```python
import torch

def _softmax(x, axis=-1):
    return torch.softmax(x, dim=axis)
def _gelu(x):
    return torch.nn.functional.gelu(x, approximate="tanh")
def _silu(x):
    return torch.nn.functional.silu(x)
def _sigmoid(x):
    return torch.sigmoid(x)
def _layernorm(x, axis=-1, eps=1e-5):
    m = x.mean(dim=axis, keepdim=True)
    v = x.var(dim=axis, keepdim=True, unbiased=False)
    return (x - m) / torch.sqrt(v + eps)
def _scatter_add(tgt, idx, src, axis=0):
    return tgt.clone().index_add_(axis, idx, src)
def _segment_sum(src, seg, n):
    out = torch.zeros((n,) + src.shape[1:], dtype=src.dtype)
    return out.index_add_(0, seg, src)
def _pad(x, pw):
    flat = tuple(v for pair in reversed(pw) for v in pair)
    return torch.nn.functional.pad(x, flat)

kernel_name = 'parallel_sum__spectral_fnet__geglu_ffn__prompt'

def setup_inputs():

    _w = (lambda a: (lambda t: t.to(torch.bfloat16) if t.is_floating_point() else t)(torch.as_tensor(a)))
    def _A_setup():
        B, S, D = 1, 2048, 640
        ns = torch.arange(S)[:, None] * torch.arange(S)[None, :]
        nd = torch.arange(D)[:, None] * torch.arange(D)[None, :]
        Ws_re = torch.cos(-2.0 * torch.pi * ns / S).to(float)
        Ws_im = torch.sin(-2.0 * torch.pi * ns / S).to(float)
        Wd_re = torch.cos(-2.0 * torch.pi * nd / D).to(float)
        Wd_im = torch.sin(-2.0 * torch.pi * nd / D).to(float)
        return {
            "x": _w((lambda *s: torch.randn(*s, dtype=torch.bfloat16) * 0.05)(B, S, D)),
            "dft_seq_re": _w(Ws_re),
            "dft_seq_im": _w(Ws_im),
            "dft_hid_re": _w(Wd_re),
            "dft_hid_im": _w(Wd_im),
        }
    _A_in = _A_setup()

    def _B_setup():
        B, S, D, F = 1, 2048, 640, 1728
        return {
            "x": _w((lambda *s: torch.randn(*s, dtype=torch.bfloat16) * 0.05)(B, S, D)),
            "w_gate": _w((lambda *s: torch.randn(*s, dtype=torch.bfloat16) * 0.2)(D, F)),
            "w_up": _w((lambda *s: torch.randn(*s, dtype=torch.bfloat16) * 0.2)(D, F)),
            "w_down": _w((lambda *s: torch.randn(*s, dtype=torch.bfloat16) * 0.2)(F, D)),
        }
    _B_in = _B_setup()

    return {
        "A_x": _A_in["x"],
        "A_dft_seq_re": _A_in["dft_seq_re"],
        "A_dft_seq_im": _A_in["dft_seq_im"],
        "A_dft_hid_re": _A_in["dft_hid_re"],
        "A_dft_hid_im": _A_in["dft_hid_im"],
        "B_x": _B_in["x"],
        "B_w_gate": _B_in["w_gate"],
        "B_w_up": _B_in["w_up"],
        "B_w_down": _B_in["w_down"],
    }

def reference(A_x, A_dft_seq_re, A_dft_seq_im, A_dft_hid_re, A_dft_hid_im, B_x, B_w_gate, B_w_up, B_w_down):
    def _A_ref(x, dft_seq_re, dft_seq_im, dft_hid_re, dft_hid_im):
        a = torch.einsum("bsd,ed->bse", x, dft_hid_re)
        b = torch.einsum("bsd,ed->bse", x, dft_hid_im)
        y = torch.einsum("ts,bse->bte", dft_seq_re, a) - torch.einsum("ts,bse->bte", dft_seq_im, b)
        return y

    def _B_ref(x, w_gate, w_up, w_down):
        return (_gelu(x @ w_gate) * (x @ w_up)) @ w_down

    x = A_x
    xn = _layernorm(x, axis=-1)
    return x + _A_ref(xn, A_dft_seq_re, A_dft_seq_im, A_dft_hid_re, A_dft_hid_im) + _B_ref(xn, B_w_gate, B_w_up, B_w_down)
```

```asm
; @launch grid=(256,1,1) block=(512,1,1) lds=163840
.amdgcn_target "amdgcn-amd-amdhsa--gfx950"
.text
.globl parallel_sum__spectral_fnet__geglu_ffn__prompt_kernel
.p2align 8
.type parallel_sum__spectral_fnet__geglu_ffn__prompt_kernel,@function
parallel_sum__spectral_fnet__geglu_ffn__prompt_kernel:
    s_cmp_ge_u32 s2, 256
    s_cbranch_scc1 L_end
    s_load_dwordx16 s[64:79], s[0:1], 0
    s_load_dwordx8 s[80:87], s[0:1], 64
    v_lshrrev_b32 v1, 6, v0
    v_and_b32 v0, 63, v0
    v_readfirstlane_b32 s42, v1
    s_and_b32 s46, s2, 7
    s_lshr_b32 s47, s2, 3
    s_lshr_b32 s40, s46, 2
    s_lshl_b32 s40, s40, 2
    s_and_b32 s48, s47, 3
    s_add_u32 s40, s40, s48
    s_lshr_b32 s45, s47, 2
    s_lshl_b32 s41, s45, 2
    s_and_b32 s47, s46, 3
    s_add_u32 s41, s41, s47
    s_mov_b32 s36, s41
    s_mov_b32 s38, s45
    s_mov_b32 s39, s45
    s_mov_b32 s29, s48
    s_lshl_b32 s44, s46, 2
    s_add_u32 s44, s44, s48
    s_cmp_ge_u32 s41, 27
    s_cselect_b32 s43, 1, 0
    s_cmp_lt_u32 s42, 4
    s_cbranch_scc1 L_cons
    s_setprio 3
    s_sub_u32 s49, s42, 4
    s_cmp_eq_u32 s42, 7
    s_cbranch_scc1 L_serv
    v_lshrrev_b32 v2, 3, v0
    v_and_b32 v3, 7, v0
    v_lshrrev_b32 v5, 1, v2
    s_lshl_b32 s63, s47, 2
    s_lshr_b32 s63, 0x8530, s63
    s_and_b32 s63, s63, 15
    s_lshr_b32 s62, s40, 2
    s_mul_i32 s62, s62, 5
    s_add_u32 s63, s63, s62
    s_cmp_ge_u32 s63, 10
    s_cselect_b32 s62, 10, 0
    s_sub_u32 s63, s63, s62
    s_cmp_eq_u32 s42, 6
    s_cbranch_scc1 L_prodw
    v_mul_u32_u24 v4, 81920, v2
    v_xor_b32 v3, v3, v5
    v_lshl_add_u32 v8, v3, 4, v4
    v_xor_b32 v9, 64, v8
    s_lshl_b32 s50, s49, 5
    s_lshl_b32 s51, s40, 2
    s_add_u32 s50, s50, s51
    s_mul_i32 s50, s50, 1280
    s_lshl_b32 s52, s63, 7
    s_add_u32 s50, s50, s52
    s_lshl_b32 s51, s49, 14
    s_lshl_b32 s57, s38, 1
    s_lshl_b32 s53, s57, 10
    s_mov_b32 s54, 0x3fff
    s_mov_b32 s55, 0
    s_mov_b32 s56, 128
    s_mov_b32 s62, 1280
    s_waitcnt lgkmcnt(0)
    s_mov_b32 s8, s64
    s_and_b32 s9, s65, 0xffff
    s_mov_b32 s10, 2621440
    s_mov_b32 s11, 0x00020000
    s_mov_b32 s12, s64
    s_and_b32 s13, s65, 0xffff
    s_mov_b32 s14, 2621440
    s_mov_b32 s15, 0x00020000
    s_add_u32 s52, s57, 0
    s_and_b32 s58, s52, 3
    s_mul_i32 s58, s58, 655360
    s_bfe_u32 s52, s52, 0x20002
    s_mul_i32 s52, s52, 1280
    s_add_u32 s52, s52, s58
    v_add_u32 v128, s52, v8
    s_add_u32 m0, s51, s53
    s_add_u32 s53, s53, 1024
    s_and_b32 s53, s53, s54
    buffer_load_dwordx4 v128, s[8:11], s50 offen lds
    s_add_u32 s52, s57, 1
    s_and_b32 s58, s52, 3
    s_mul_i32 s58, s58, 655360
    s_bfe_u32 s52, s52, 0x20002
    s_mul_i32 s52, s52, 1280
    s_add_u32 s52, s52, s58
    v_add_u32 v129, s52, v9
    s_add_u32 m0, s51, s53
    s_add_u32 s53, s53, 1024
    s_and_b32 s53, s53, s54
    buffer_load_dwordx4 v129, s[8:11], s50 offen lds
    s_add_u32 s52, s57, 2
    s_and_b32 s58, s52, 3
    s_mul_i32 s58, s58, 655360
    s_bfe_u32 s52, s52, 0x20002
    s_mul_i32 s52, s52, 1280
    s_add_u32 s52, s52, s58
    v_add_u32 v130, s52, v8
    s_add_u32 m0, s51, s53
    s_add_u32 s53, s53, 1024
    s_and_b32 s53, s53, s54
    buffer_load_dwordx4 v130, s[8:11], s50 offen lds
    s_add_u32 s52, s57, 3
    s_and_b32 s58, s52, 3
    s_mul_i32 s58, s58, 655360
    s_bfe_u32 s52, s52, 0x20002
    s_mul_i32 s52, s52, 1280
    s_add_u32 s52, s52, s58
    v_add_u32 v131, s52, v9
    s_add_u32 m0, s51, s53
    s_add_u32 s53, s53, 1024
    s_and_b32 s53, s53, s54
    buffer_load_dwordx4 v131, s[8:11], s50 offen lds
    s_add_u32 s52, s57, 4
    s_and_b32 s58, s52, 3
    s_mul_i32 s58, s58, 655360
    s_bfe_u32 s52, s52, 0x20002
    s_mul_i32 s52, s52, 1280
    s_add_u32 s52, s52, s58
    v_add_u32 v132, s52, v8
    s_add_u32 m0, s51, s53
    s_add_u32 s53, s53, 1024
    s_and_b32 s53, s53, s54
    buffer_load_dwordx4 v132, s[8:11], s50 offen lds
    s_add_u32 s52, s57, 5
    s_and_b32 s58, s52, 3
    s_mul_i32 s58, s58, 655360
    s_bfe_u32 s52, s52, 0x20002
    s_mul_i32 s52, s52, 1280
    s_add_u32 s52, s52, s58
    v_add_u32 v133, s52, v9
    s_add_u32 m0, s51, s53
    s_add_u32 s53, s53, 1024
    s_and_b32 s53, s53, s54
    buffer_load_dwordx4 v133, s[8:11], s50 offen lds
    s_add_u32 s52, s57, 6
    s_and_b32 s58, s52, 3
    s_mul_i32 s58, s58, 655360
    s_bfe_u32 s52, s52, 0x20002
    s_mul_i32 s52, s52, 1280
    s_add_u32 s52, s52, s58
    v_add_u32 v134, s52, v8
    s_add_u32 m0, s51, s53
    s_add_u32 s53, s53, 1024
    s_and_b32 s53, s53, s54
    buffer_load_dwordx4 v134, s[8:11], s50 offen lds
    s_add_u32 s52, s57, 7
    s_and_b32 s58, s52, 3
    s_mul_i32 s58, s58, 655360
    s_bfe_u32 s52, s52, 0x20002
    s_mul_i32 s52, s52, 1280
    s_add_u32 s52, s52, s58
    v_add_u32 v135, s52, v9
    s_add_u32 m0, s51, s53
    s_add_u32 s53, s53, 1024
    s_and_b32 s53, s53, s54
    buffer_load_dwordx4 v135, s[8:11], s50 offen lds
    s_add_u32 s52, s57, 8
    s_and_b32 s58, s52, 3
    s_mul_i32 s58, s58, 655360
    s_bfe_u32 s52, s52, 0x20002
    s_mul_i32 s52, s52, 1280
    s_add_u32 s52, s52, s58
    v_add_u32 v136, s52, v8
    s_add_u32 m0, s51, s53
    s_add_u32 s53, s53, 1024
    s_and_b32 s53, s53, s54
    buffer_load_dwordx4 v136, s[12:15], s50 offen lds
    s_add_u32 s52, s57, 9
    s_and_b32 s58, s52, 3
    s_mul_i32 s58, s58, 655360
    s_bfe_u32 s52, s52, 0x20002
    s_mul_i32 s52, s52, 1280
    s_add_u32 s52, s52, s58
    v_add_u32 v137, s52, v9
    s_add_u32 m0, s51, s53
    s_add_u32 s53, s53, 1024
    s_and_b32 s53, s53, s54
    buffer_load_dwordx4 v137, s[12:15], s50 offen lds
    s_add_u32 s52, s57, 10
    s_and_b32 s58, s52, 3
    s_mul_i32 s58, s58, 655360
    s_bfe_u32 s52, s52, 0x20002
    s_mul_i32 s52, s52, 1280
    s_add_u32 s52, s52, s58
    v_add_u32 v138, s52, v8
    s_add_u32 m0, s51, s53
    s_add_u32 s53, s53, 1024
    s_and_b32 s53, s53, s54
    buffer_load_dwordx4 v138, s[12:15], s50 offen lds
    s_add_u32 s52, s57, 11
    s_and_b32 s58, s52, 3
    s_mul_i32 s58, s58, 655360
    s_bfe_u32 s52, s52, 0x20002
    s_mul_i32 s52, s52, 1280
    s_add_u32 s52, s52, s58
    v_add_u32 v139, s52, v9
    s_add_u32 m0, s51, s53
    s_add_u32 s53, s53, 1024
    s_and_b32 s53, s53, s54
    buffer_load_dwordx4 v139, s[12:15], s50 offen lds
    s_add_u32 s52, s57, 12
    s_and_b32 s58, s52, 3
    s_mul_i32 s58, s58, 655360
    s_bfe_u32 s52, s52, 0x20002
    s_mul_i32 s52, s52, 1280
    s_add_u32 s52, s52, s58
    v_add_u32 v140, s52, v8
    s_add_u32 m0, s51, s53
    s_add_u32 s53, s53, 1024
    s_and_b32 s53, s53, s54
    buffer_load_dwordx4 v140, s[12:15], s50 offen lds
    s_add_u32 s52, s57, 13
    s_and_b32 s58, s52, 3
    s_mul_i32 s58, s58, 655360
    s_bfe_u32 s52, s52, 0x20002
    s_mul_i32 s52, s52, 1280
    s_add_u32 s52, s52, s58
    v_add_u32 v141, s52, v9
    s_add_u32 m0, s51, s53
    s_add_u32 s53, s53, 1024
    s_and_b32 s53, s53, s54
    buffer_load_dwordx4 v141, s[12:15], s50 offen lds
    s_add_u32 s52, s57, 14
    s_and_b32 s58, s52, 3
    s_mul_i32 s58, s58, 655360
    s_bfe_u32 s52, s52, 0x20002
    s_mul_i32 s52, s52, 1280
    s_add_u32 s52, s52, s58
    v_add_u32 v142, s52, v8
    s_add_u32 m0, s51, s53
    s_add_u32 s53, s53, 1024
    s_and_b32 s53, s53, s54
    buffer_load_dwordx4 v142, s[12:15], s50 offen lds
    s_add_u32 s52, s57, 15
    s_and_b32 s58, s52, 3
    s_mul_i32 s58, s58, 655360
    s_bfe_u32 s52, s52, 0x20002
    s_mul_i32 s52, s52, 1280
    s_add_u32 s52, s52, s58
    v_add_u32 v143, s52, v9
    s_add_u32 m0, s51, s53
    s_add_u32 s53, s53, 1024
    s_and_b32 s53, s53, s54
    buffer_load_dwordx4 v143, s[12:15], s50 offen lds
    s_branch L_pfirst
L_prodw:
    s_mov_b32 s51, 32768
    s_lshl_b32 s57, s48, 1
    s_lshl_b32 s53, s57, 10
    s_mov_b32 s54, 0x1fff
    s_mov_b32 s55, 8192
    s_cmp_eq_u32 s43, 1
    s_cbranch_scc1 L_prodw_dft
    v_mul_u32_u24 v4, 3456, v2
    v_and_b32 v5, 1, v5
    v_lshlrev_b32 v5, 1, v5
    v_xor_b32 v3, v3, v5
    v_lshl_add_u32 v8, v3, 4, v4
    v_xor_b32 v9, 64, v8
    s_lshl_b32 s50, s41, 7
    s_mov_b32 s58, 27648
    s_mov_b32 s56, 221184
    s_waitcnt lgkmcnt(0)
    s_mov_b32 s8, s76
    s_and_b32 s9, s77, 0xffff
    s_mov_b32 s10, 2211840
    s_mov_b32 s11, 0x00020000
    s_mov_b32 s12, s78
    s_and_b32 s13, s79, 0xffff
    s_mov_b32 s14, 2211840
    s_mov_b32 s15, 0x00020000
    s_branch L_prodw_go
L_prodw_dft:
    v_mul_u32_u24 v4, 1280, v2
    v_xor_b32 v3, v3, v5
    v_lshl_add_u32 v8, v3, 4, v4
    v_xor_b32 v9, 64, v8
    s_sub_u32 s50, s41, 27
    s_lshl_b32 s50, s50, 6
    s_add_u32 s50, s50, 1
    s_mul_i32 s50, s50, 1280
    s_mov_b32 s58, 10240
    s_mov_b32 s56, 128
    s_waitcnt lgkmcnt(0)
    s_mov_b32 s8, s70
    s_and_b32 s9, s71, 0xffff
    s_mov_b32 s10, 819200
    s_mov_b32 s11, 0x00020000
    s_mov_b32 s12, s72
    s_and_b32 s13, s73, 0xffff
    s_mov_b32 s14, 819200
    s_mov_b32 s15, 0x00020000
L_prodw_go:
    s_mul_i32 s52, s63, s56
    s_add_u32 s50, s50, s52
    s_mul_i32 s62, s56, 10
    s_add_u32 s52, s57, 0
    s_and_b32 s52, s52, 7
    s_mul_i32 s52, s52, s58
    v_add_u32 v128, s52, v8
    v_add_u32 v136, s52, v8
    s_add_u32 m0, s51, s53
    s_add_u32 s53, s53, 1024
    s_and_b32 s53, s53, s54
    buffer_load_dwordx4 v128, s[8:11], s50 offen lds
    s_add_u32 s52, s57, 1
    s_and_b32 s52, s52, 7
    s_mul_i32 s52, s52, s58
    v_add_u32 v129, s52, v9
    v_add_u32 v137, s52, v9
    s_add_u32 m0, s51, s53
    s_add_u32 s53, s53, 1024
    s_and_b32 s53, s53, s54
    buffer_load_dwordx4 v129, s[8:11], s50 offen lds
    s_add_u32 s52, s57, 2
    s_and_b32 s52, s52, 7
    s_mul_i32 s52, s52, s58
    v_add_u32 v130, s52, v8
    v_add_u32 v138, s52, v8
    s_add_u32 m0, s51, s53
    s_add_u32 s53, s53, 1024
    s_and_b32 s53, s53, s54
    buffer_load_dwordx4 v130, s[8:11], s50 offen lds
    s_add_u32 s52, s57, 3
    s_and_b32 s52, s52, 7
    s_mul_i32 s52, s52, s58
    v_add_u32 v131, s52, v9
    v_add_u32 v139, s52, v9
    s_add_u32 m0, s51, s53
    s_add_u32 s53, s53, 1024
    s_and_b32 s53, s53, s54
    buffer_load_dwordx4 v131, s[8:11], s50 offen lds
    s_add_u32 s52, s57, 4
    s_and_b32 s52, s52, 7
    s_mul_i32 s52, s52, s58
    v_add_u32 v132, s52, v8
    v_add_u32 v140, s52, v8
    s_add_u32 m0, s51, s53
    s_add_u32 s53, s53, 1024
    s_and_b32 s53, s53, s54
    buffer_load_dwordx4 v132, s[8:11], s50 offen lds
    s_add_u32 s52, s57, 5
    s_and_b32 s52, s52, 7
    s_mul_i32 s52, s52, s58
    v_add_u32 v133, s52, v9
    v_add_u32 v141, s52, v9
    s_add_u32 m0, s51, s53
    s_add_u32 s53, s53, 1024
    s_and_b32 s53, s53, s54
    buffer_load_dwordx4 v133, s[8:11], s50 offen lds
    s_add_u32 s52, s57, 6
    s_and_b32 s52, s52, 7
    s_mul_i32 s52, s52, s58
    v_add_u32 v134, s52, v8
    v_add_u32 v142, s52, v8
    s_add_u32 m0, s51, s53
    s_add_u32 s53, s53, 1024
    s_and_b32 s53, s53, s54
    buffer_load_dwordx4 v134, s[8:11], s50 offen lds
    s_add_u32 s52, s57, 7
    s_and_b32 s52, s52, 7
    s_mul_i32 s52, s52, s58
    v_add_u32 v135, s52, v9
    v_add_u32 v143, s52, v9
    s_add_u32 m0, s51, s53
    s_add_u32 s53, s53, 1024
    s_and_b32 s53, s53, s54
    buffer_load_dwordx4 v135, s[8:11], s50 offen lds
    s_add_u32 s51, s51, s55
    s_add_u32 m0, s51, s53
    s_add_u32 s53, s53, 1024
    s_and_b32 s53, s53, s54
    buffer_load_dwordx4 v136, s[12:15], s50 offen lds
    s_add_u32 m0, s51, s53
    s_add_u32 s53, s53, 1024
    s_and_b32 s53, s53, s54
    buffer_load_dwordx4 v137, s[12:15], s50 offen lds
    s_add_u32 m0, s51, s53
    s_add_u32 s53, s53, 1024
    s_and_b32 s53, s53, s54
    buffer_load_dwordx4 v138, s[12:15], s50 offen lds
    s_add_u32 m0, s51, s53
    s_add_u32 s53, s53, 1024
    s_and_b32 s53, s53, s54
    buffer_load_dwordx4 v139, s[12:15], s50 offen lds
    s_add_u32 m0, s51, s53
    s_add_u32 s53, s53, 1024
    s_and_b32 s53, s53, s54
    buffer_load_dwordx4 v140, s[12:15], s50 offen lds
    s_add_u32 m0, s51, s53
    s_add_u32 s53, s53, 1024
    s_and_b32 s53, s53, s54
    buffer_load_dwordx4 v141, s[12:15], s50 offen lds
    s_add_u32 m0, s51, s53
    s_add_u32 s53, s53, 1024
    s_and_b32 s53, s53, s54
    buffer_load_dwordx4 v142, s[12:15], s50 offen lds
    s_add_u32 m0, s51, s53
    s_add_u32 s53, s53, 1024
    s_and_b32 s53, s53, s54
    buffer_load_dwordx4 v143, s[12:15], s50 offen lds
L_pfirst:
    s_mov_b32 s16, s86
    s_and_b32 s17, s87, 0xffff
    s_mov_b32 s18, 16777216
    s_mov_b32 s19, 0x00020000
    v_lshlrev_b32 v1, 4, v0
    s_mul_i32 s24, s45, 276480
    s_add_u32 s24, s24, 65536
    s_mul_i32 s28, s39, 4
    s_lshr_b32 s28, s28, 2
    s_add_u32 s28, s28, s29
    s_cmp_ge_u32 s28, 6
    s_cselect_b32 s30, 6, 0
    s_sub_u32 s28, s28, s30
    s_mul_i32 s26, s49, 6
    s_add_u32 s26, s26, 30
    s_mul_i32 s25, s26, 5120
    s_add_u32 s25, s25, s24
    s_lshl_b32 s26, s26, 17
    s_lshl_b32 s27, s44, 12
    s_add_u32 s26, s26, s27
    s_add_u32 s26, s26, 4194304
    s_mov_b32 s27, s28
    v_mov_b32 v144, 162304
    s_mov_b32 s60, 0
    s_branch L_pnext
L_ploop:
    s_add_u32 m0, s51, s53
    s_add_u32 s53, s53, 1024
    s_and_b32 s53, s53, s54
    buffer_load_dwordx4 v128, s[8:11], s50 offen lds
    s_add_u32 m0, s51, s53
    s_add_u32 s53, s53, 1024
    s_and_b32 s53, s53, s54
    buffer_load_dwordx4 v129, s[8:11], s50 offen lds
    s_add_u32 m0, s51, s53
    s_add_u32 s53, s53, 1024
    s_and_b32 s53, s53, s54
    buffer_load_dwordx4 v130, s[8:11], s50 offen lds
    s_add_u32 m0, s51, s53
    s_add_u32 s53, s53, 1024
    s_and_b32 s53, s53, s54
    buffer_load_dwordx4 v131, s[8:11], s50 offen lds
    s_add_u32 m0, s51, s53
    s_add_u32 s53, s53, 1024
    s_and_b32 s53, s53, s54
    buffer_load_dwordx4 v132, s[8:11], s50 offen lds
    s_add_u32 m0, s51, s53
    s_add_u32 s53, s53, 1024
    s_and_b32 s53, s53, s54
    buffer_load_dwordx4 v133, s[8:11], s50 offen lds
    s_add_u32 m0, s51, s53
    s_add_u32 s53, s53, 1024
    s_and_b32 s53, s53, s54
    buffer_load_dwordx4 v134, s[8:11], s50 offen lds
    s_add_u32 m0, s51, s53
    s_add_u32 s53, s53, 1024
    s_and_b32 s53, s53, s54
    buffer_load_dwordx4 v135, s[8:11], s50 offen lds
    s_add_u32 s51, s51, s55
    s_add_u32 m0, s51, s53
    s_add_u32 s53, s53, 1024
    s_and_b32 s53, s53, s54
    buffer_load_dwordx4 v136, s[12:15], s50 offen lds
    s_add_u32 m0, s51, s53
    s_add_u32 s53, s53, 1024
    s_and_b32 s53, s53, s54
    buffer_load_dwordx4 v137, s[12:15], s50 offen lds
    s_add_u32 m0, s51, s53
    s_add_u32 s53, s53, 1024
    s_and_b32 s53, s53, s54
    buffer_load_dwordx4 v138, s[12:15], s50 offen lds
    s_add_u32 m0, s51, s53
    s_add_u32 s53, s53, 1024
    s_and_b32 s53, s53, s54
    buffer_load_dwordx4 v139, s[12:15], s50 offen lds
    s_add_u32 m0, s51, s53
    s_add_u32 s53, s53, 1024
    s_and_b32 s53, s53, s54
    buffer_load_dwordx4 v140, s[12:15], s50 offen lds
    s_add_u32 m0, s51, s53
    s_add_u32 s53, s53, 1024
    s_and_b32 s53, s53, s54
    buffer_load_dwordx4 v141, s[12:15], s50 offen lds
    s_add_u32 m0, s51, s53
    s_add_u32 s53, s53, 1024
    s_and_b32 s53, s53, s54
    buffer_load_dwordx4 v142, s[12:15], s50 offen lds
    s_add_u32 m0, s51, s53
    s_add_u32 s53, s53, 1024
    s_and_b32 s53, s53, s54
    buffer_load_dwordx4 v143, s[12:15], s50 offen lds
L_pnext:
    s_sub_u32 s51, s51, s55
    s_add_u32 s50, s50, s56
    s_add_u32 s63, s63, 1
    s_cmp_eq_u32 s63, 10
    s_cselect_b32 s63, 0, s63
    s_cselect_b32 s52, s62, 0
    s_sub_u32 s50, s50, s52
    s_add_u32 s51, s51, 49152
    s_cmp_ge_u32 s51, 147456
    s_cselect_b32 s52, 147456, 0
    s_sub_u32 s51, s51, s52
    s_add_u32 s60, s60, 1
    s_cmp_lt_u32 s60, 2
    s_cbranch_scc1 L_ploop
    s_waitcnt vmcnt(16)
    s_barrier
    s_cmp_lt_u32 s60, 10
    s_cbranch_scc1 L_ploop
    v_mov_b32 v144, 162304
    s_sleep 3
    ds_read_b32 v145, v144 offset:16
    s_waitcnt lgkmcnt(0)
    v_cmp_eq_u32 vcc, 0, v145
    s_cbranch_vccnz L_lnd0
    s_mul_i32 s30, s27, 5120
    s_add_u32 s30, s30, s25
    s_add_u32 s31, s30, 4096
    buffer_load_dwordx4 v[8:11], v1, s[16:19], s30 offen offset:0 sc1
    buffer_load_dwordx4 v[12:15], v1, s[16:19], s30 offen offset:1024 sc1
    buffer_load_dwordx4 v[16:19], v1, s[16:19], s30 offen offset:2048 sc1
    buffer_load_dwordx4 v[20:23], v1, s[16:19], s30 offen offset:3072 sc1
    buffer_load_dwordx4 v[24:27], v1, s[16:19], s31 offen sc1
    s_add_u32 s27, s27, 1
    s_cmp_eq_u32 s27, 6
    s_cselect_b32 s27, 0, s27
    s_mul_i32 s30, s27, 5120
    s_add_u32 s30, s30, s25
    s_add_u32 s31, s30, 4096
    buffer_load_dwordx4 v[28:31], v1, s[16:19], s30 offen offset:0 sc1
    buffer_load_dwordx4 v[32:35], v1, s[16:19], s30 offen offset:1024 sc1
    buffer_load_dwordx4 v[36:39], v1, s[16:19], s30 offen offset:2048 sc1
    buffer_load_dwordx4 v[40:43], v1, s[16:19], s30 offen offset:3072 sc1
    buffer_load_dwordx4 v[44:47], v1, s[16:19], s31 offen sc1
    s_add_u32 s27, s27, 1
    s_cmp_eq_u32 s27, 6
    s_cselect_b32 s27, 0, s27
    s_waitcnt vmcnt(10)
    v_mov_b32 v144, 162316
    v_mov_b32 v145, 1
    s_mov_b64 exec, 1
    ds_add_u32 v144, v145
    s_mov_b64 exec, -1
    s_branch L_lnd1
L_lnd0:
    s_waitcnt vmcnt(0)
    v_mov_b32 v144, 162316
    v_mov_b32 v145, 1
    s_mov_b64 exec, 1
    ds_add_u32 v144, v145
    s_mov_b64 exec, -1
    v_mov_b32 v144, 162320
    s_mov_b32 s60, 0
L_wok:
    ds_read_b32 v145, v144
    s_add_u32 s60, s60, 1
    s_waitcnt lgkmcnt(0)
    v_cmp_gt_u32 vcc, 1, v145
    s_cbranch_vccz L_wokd
    s_sleep 1
    s_cmp_lt_u32 s60, 0x400000
    s_cbranch_scc1 L_wok
L_wokd:
    s_mul_i32 s30, s27, 5120
    s_add_u32 s30, s30, s25
    s_add_u32 s31, s30, 4096
    buffer_load_dwordx4 v[8:11], v1, s[16:19], s30 offen offset:0 sc1
    buffer_load_dwordx4 v[12:15], v1, s[16:19], s30 offen offset:1024 sc1
    buffer_load_dwordx4 v[16:19], v1, s[16:19], s30 offen offset:2048 sc1
    buffer_load_dwordx4 v[20:23], v1, s[16:19], s30 offen offset:3072 sc1
    buffer_load_dwordx4 v[24:27], v1, s[16:19], s31 offen sc1
    s_add_u32 s27, s27, 1
    s_cmp_eq_u32 s27, 6
    s_cselect_b32 s27, 0, s27
    s_mul_i32 s30, s27, 5120
    s_add_u32 s30, s30, s25
    s_add_u32 s31, s30, 4096
    buffer_load_dwordx4 v[28:31], v1, s[16:19], s30 offen offset:0 sc1
    buffer_load_dwordx4 v[32:35], v1, s[16:19], s30 offen offset:1024 sc1
    buffer_load_dwordx4 v[36:39], v1, s[16:19], s30 offen offset:2048 sc1
    buffer_load_dwordx4 v[40:43], v1, s[16:19], s30 offen offset:3072 sc1
    buffer_load_dwordx4 v[44:47], v1, s[16:19], s31 offen sc1
    s_add_u32 s27, s27, 1
    s_cmp_eq_u32 s27, 6
    s_cselect_b32 s27, 0, s27
L_lnd1:
    s_mul_i32 s50, s49, 16384
    s_add_u32 s50, s50, 49152
    s_and_b32 s51, s29, 3
    s_lshl_b32 s51, s51, 12
    s_add_u32 m0, s50, s51
    s_add_u32 s52, m0, s24
    s_add_u32 s51, s51, 4096
    s_and_b32 s51, s51, 0x3fff
    buffer_load_dwordx4 v1, s[16:19], s52 offen offset:0 sc1 lds
    buffer_load_dwordx4 v1, s[16:19], s52 offen offset:1024 sc1 lds
    buffer_load_dwordx4 v1, s[16:19], s52 offen offset:2048 sc1 lds
    buffer_load_dwordx4 v1, s[16:19], s52 offen offset:3072 sc1 lds
    s_add_u32 m0, s50, s51
    s_add_u32 s52, m0, s24
    s_add_u32 s51, s51, 4096
    s_and_b32 s51, s51, 0x3fff
    buffer_load_dwordx4 v1, s[16:19], s52 offen offset:0 sc1 lds
    buffer_load_dwordx4 v1, s[16:19], s52 offen offset:1024 sc1 lds
    buffer_load_dwordx4 v1, s[16:19], s52 offen offset:2048 sc1 lds
    buffer_load_dwordx4 v1, s[16:19], s52 offen offset:3072 sc1 lds
    s_add_u32 m0, s50, s51
    s_add_u32 s52, m0, s24
    s_add_u32 s51, s51, 4096
    s_and_b32 s51, s51, 0x3fff
    buffer_load_dwordx4 v1, s[16:19], s52 offen offset:0 sc1 lds
    buffer_load_dwordx4 v1, s[16:19], s52 offen offset:1024 sc1 lds
    buffer_load_dwordx4 v1, s[16:19], s52 offen offset:2048 sc1 lds
    buffer_load_dwordx4 v1, s[16:19], s52 offen offset:3072 sc1 lds
    s_add_u32 m0, s50, s51
    s_add_u32 s52, m0, s24
    s_add_u32 s51, s51, 4096
    s_and_b32 s51, s51, 0x3fff
    buffer_load_dwordx4 v1, s[16:19], s52 offen offset:0 sc1 lds
    buffer_load_dwordx4 v1, s[16:19], s52 offen offset:1024 sc1 lds
    buffer_load_dwordx4 v1, s[16:19], s52 offen offset:2048 sc1 lds
    buffer_load_dwordx4 v1, s[16:19], s52 offen offset:3072 sc1 lds
    s_mov_b32 s4, s64
    s_and_b32 s5, s65, 0xffff
    s_mov_b32 s6, 2621440
    s_mov_b32 s7, 0x00020000
    v_and_b32 v2, 15, v0
    v_lshlrev_b32 v2, 6, v2
    v_add_u32 v2, s44, v2
    v_mul_u32_u24 v2, 1280, v2
    v_lshrrev_b32 v3, 4, v0
    v_lshl_add_u32 v2, v3, 3, v2
    s_and_b32 s30, s49, 1
    s_mul_i32 s30, s30, 1310720
    s_lshr_b32 s31, s49, 1
    s_mul_i32 s31, s31, 40960
    s_add_u32 s30, s30, s31
    s_mul_i32 s31, s45, 160
    s_add_u32 s30, s30, s31
    buffer_load_dwordx2 v[160:161], v2, s[4:7], s30 offen offset:0
    buffer_load_dwordx2 v[162:163], v2, s[4:7], s30 offen offset:32
    buffer_load_dwordx2 v[164:165], v2, s[4:7], s30 offen offset:64
    buffer_load_dwordx2 v[166:167], v2, s[4:7], s30 offen offset:96
    buffer_load_dwordx2 v[168:169], v2, s[4:7], s30 offen offset:128
    v_mov_b32 v144, 162308
    s_mov_b32 s60, 0
L_pr4:
    ds_read_b32 v145, v144
    s_add_u32 s60, s60, 1
    s_waitcnt lgkmcnt(0)
    v_cmp_gt_u32 vcc, 4, v145
    s_cbranch_vccz L_pr4d
    s_sleep 1
    s_cmp_lt_u32 s60, 0x400000
    s_cbranch_scc1 L_pr4
L_pr4d:
    s_waitcnt vmcnt(40)
    s_mul_i32 s50, s49, 18432
    s_add_u32 s50, s50, 98304
    s_and_b32 s51, s29, 3
    s_lshl_b32 s51, s51, 12
    s_waitcnt vmcnt(4)
    s_add_u32 m0, s50, s51
    s_add_u32 s52, m0, s24
    s_add_u32 s51, s51, 4096
    s_and_b32 s51, s51, 0x3fff
    buffer_load_dwordx4 v1, s[16:19], s52 offen offset:0 sc1 lds
    buffer_load_dwordx4 v1, s[16:19], s52 offen offset:1024 sc1 lds
    buffer_load_dwordx4 v1, s[16:19], s52 offen offset:2048 sc1 lds
    buffer_load_dwordx4 v1, s[16:19], s52 offen offset:3072 sc1 lds
    s_waitcnt vmcnt(4)
    s_add_u32 m0, s50, s51
    s_add_u32 s52, m0, s24
    s_add_u32 s51, s51, 4096
    s_and_b32 s51, s51, 0x3fff
    buffer_load_dwordx4 v1, s[16:19], s52 offen offset:0 sc1 lds
    buffer_load_dwordx4 v1, s[16:19], s52 offen offset:1024 sc1 lds
    buffer_load_dwordx4 v1, s[16:19], s52 offen offset:2048 sc1 lds
    buffer_load_dwordx4 v1, s[16:19], s52 offen offset:3072 sc1 lds
    s_waitcnt vmcnt(4)
    s_add_u32 m0, s50, s51
    s_add_u32 s52, m0, s24
    s_add_u32 s51, s51, 4096
    s_and_b32 s51, s51, 0x3fff
    buffer_load_dwordx4 v1, s[16:19], s52 offen offset:0 sc1 lds
    buffer_load_dwordx4 v1, s[16:19], s52 offen offset:1024 sc1 lds
    buffer_load_dwordx4 v1, s[16:19], s52 offen offset:2048 sc1 lds
    buffer_load_dwordx4 v1, s[16:19], s52 offen offset:3072 sc1 lds
    s_waitcnt vmcnt(4)
    s_add_u32 m0, s50, s51
    s_add_u32 s52, m0, s24
    s_add_u32 s51, s51, 4096
    s_and_b32 s51, s51, 0x3fff
    buffer_load_dwordx4 v1, s[16:19], s52 offen offset:0 sc1 lds
    buffer_load_dwordx4 v1, s[16:19], s52 offen offset:1024 sc1 lds
    buffer_load_dwordx4 v1, s[16:19], s52 offen offset:2048 sc1 lds
    buffer_load_dwordx4 v1, s[16:19], s52 offen offset:3072 sc1 lds
    s_add_u32 m0, s50, 16384
    s_add_u32 s52, m0, s24
    buffer_load_dwordx4 v1, s[16:19], s52 offen offset:0 sc1 lds
    buffer_load_dwordx4 v1, s[16:19], s52 offen offset:1024 sc1 lds
    v_mov_b32 v144, 162308
    s_mov_b32 s60, 0
L_pr8:
    ds_read_b32 v145, v144
    s_add_u32 s60, s60, 1
    s_waitcnt lgkmcnt(0)
    v_cmp_gt_u32 vcc, 8, v145
    s_cbranch_vccz L_pr8d
    s_sleep 1
    s_cmp_lt_u32 s60, 0x400000
    s_cbranch_scc1 L_pr8
L_pr8d:
    s_setprio 0
    s_waitcnt vmcnt(4)
    s_mul_i32 s30, s27, 5120
    s_add_u32 s30, s30, s25
    s_add_u32 s31, s30, 4096
    buffer_load_dwordx4 v[48:51], v1, s[16:19], s30 offen offset:0 sc1
    buffer_load_dwordx4 v[52:55], v1, s[16:19], s30 offen offset:1024 sc1
    buffer_load_dwordx4 v[56:59], v1, s[16:19], s30 offen offset:2048 sc1
    buffer_load_dwordx4 v[60:63], v1, s[16:19], s30 offen offset:3072 sc1
    buffer_load_dwordx4 v[64:67], v1, s[16:19], s31 offen sc1
    s_add_u32 s27, s27, 1
    s_cmp_eq_u32 s27, 6
    s_cselect_b32 s27, 0, s27
    s_cmp_eq_u32 s43, 1
    s_cbranch_scc1 L_ppdd
    v_mov_b32 v144, 162304
    s_mov_b32 s60, 0
L_ppd:
    ds_read_b32 v145, v144
    s_add_u32 s60, s60, 1
    s_waitcnt lgkmcnt(0)
    v_cmp_gt_u32 vcc, 4, v145
    s_cbranch_vccz L_ppdd
    s_sleep 1
    s_cmp_lt_u32 s60, 0x400000
    s_cbranch_scc1 L_ppd
L_ppdd:
    s_waitcnt vmcnt(40)
    s_mul_i32 s50, s49, 16384
    s_add_u32 s50, s50, 0
    s_and_b32 s51, s29, 3
    s_lshl_b32 s51, s51, 12
    s_add_u32 m0, s50, s51
    s_add_u32 s52, m0, s24
    s_add_u32 s51, s51, 4096
    s_and_b32 s51, s51, 0x3fff
    buffer_load_dwordx4 v1, s[16:19], s52 offen offset:0 sc1 lds
    buffer_load_dwordx4 v1, s[16:19], s52 offen offset:1024 sc1 lds
    buffer_load_dwordx4 v1, s[16:19], s52 offen offset:2048 sc1 lds
    buffer_load_dwordx4 v1, s[16:19], s52 offen offset:3072 sc1 lds
    s_add_u32 m0, s50, s51
    s_add_u32 s52, m0, s24
    s_add_u32 s51, s51, 4096
    s_and_b32 s51, s51, 0x3fff
    buffer_load_dwordx4 v1, s[16:19], s52 offen offset:0 sc1 lds
    buffer_load_dwordx4 v1, s[16:19], s52 offen offset:1024 sc1 lds
    buffer_load_dwordx4 v1, s[16:19], s52 offen offset:2048 sc1 lds
    buffer_load_dwordx4 v1, s[16:19], s52 offen offset:3072 sc1 lds
    s_add_u32 m0, s50, s51
    s_add_u32 s52, m0, s24
    s_add_u32 s51, s51, 4096
    s_and_b32 s51, s51, 0x3fff
    buffer_load_dwordx4 v1, s[16:19], s52 offen offset:0 sc1 lds
    buffer_load_dwordx4 v1, s[16:19], s52 offen offset:1024 sc1 lds
    buffer_load_dwordx4 v1, s[16:19], s52 offen offset:2048 sc1 lds
    buffer_load_dwordx4 v1, s[16:19], s52 offen offset:3072 sc1 lds
    s_add_u32 m0, s50, s51
    s_add_u32 s52, m0, s24
    s_add_u32 s51, s51, 4096
    s_and_b32 s51, s51, 0x3fff
    buffer_load_dwordx4 v1, s[16:19], s52 offen offset:0 sc1 lds
    buffer_load_dwordx4 v1, s[16:19], s52 offen offset:1024 sc1 lds
    buffer_load_dwordx4 v1, s[16:19], s52 offen offset:2048 sc1 lds
    buffer_load_dwordx4 v1, s[16:19], s52 offen offset:3072 sc1 lds
    s_mul_i32 s30, s27, 5120
    s_add_u32 s30, s30, s25
    s_add_u32 s31, s30, 4096
    buffer_load_dwordx4 v[68:71], v1, s[16:19], s30 offen offset:0 sc1
    buffer_load_dwordx4 v[72:75], v1, s[16:19], s30 offen offset:1024 sc1
    buffer_load_dwordx4 v[76:79], v1, s[16:19], s30 offen offset:2048 sc1
    buffer_load_dwordx4 v[80:83], v1, s[16:19], s30 offen offset:3072 sc1
    buffer_load_dwordx4 v[84:87], v1, s[16:19], s31 offen sc1
    s_add_u32 s27, s27, 1
    s_cmp_eq_u32 s27, 6
    s_cselect_b32 s27, 0, s27
    s_mul_i32 s30, s27, 5120
    s_add_u32 s30, s30, s25
    s_add_u32 s31, s30, 4096
    buffer_load_dwordx4 v[88:91], v1, s[16:19], s30 offen offset:0 sc1
    buffer_load_dwordx4 v[92:95], v1, s[16:19], s30 offen offset:1024 sc1
    buffer_load_dwordx4 v[96:99], v1, s[16:19], s30 offen offset:2048 sc1
    buffer_load_dwordx4 v[100:103], v1, s[16:19], s30 offen offset:3072 sc1
    buffer_load_dwordx4 v[104:107], v1, s[16:19], s31 offen sc1
    s_add_u32 s27, s27, 1
    s_cmp_eq_u32 s27, 6
    s_cselect_b32 s27, 0, s27
    s_mul_i32 s30, s27, 5120
    s_add_u32 s30, s30, s25
    s_add_u32 s31, s30, 4096
    buffer_load_dwordx4 v[108:111], v1, s[16:19], s30 offen offset:0 sc1
    buffer_load_dwordx4 v[112:115], v1, s[16:19], s30 offen offset:1024 sc1
    buffer_load_dwordx4 v[116:119], v1, s[16:19], s30 offen offset:2048 sc1
    buffer_load_dwordx4 v[120:123], v1, s[16:19], s30 offen offset:3072 sc1
    buffer_load_dwordx4 v[124:127], v1, s[16:19], s31 offen sc1
    s_add_u32 s27, s27, 1
    s_cmp_eq_u32 s27, 6
    s_cselect_b32 s27, 0, s27
    s_waitcnt vmcnt(15)
    v_mov_b32 v144, 162332
    v_mov_b32 v145, 1
    s_mov_b64 exec, 1
    ds_add_u32 v144, v145
    s_mov_b64 exec, -1
    s_cmp_ge_u32 s45, 4
    s_cselect_b32 s58, -1, 0
    s_and_b32 s57, s58, 1
    v_and_b32 v2, 15, v0
    v_lshlrev_b32 v144, 6, v2
    v_add_u32 v144, s44, v144
    v_lshrrev_b32 v3, 4, v0
    s_lshl_b32 s52, s49, 4
    v_lshl_add_u32 v145, v3, 2, s52
    v_add_u32 v146, 0, v144
    v_xor_b32 v146, s58, v146
    v_add_u32 v146, s57, v146
    v_and_b32 v146, 2047, v146
    v_mul_u32_u24 v148, v146, v145
    v_add_u32 v149, v148, v146
    v_add_u32 v150, v149, v146
    v_add_u32 v151, v150, v146
    v_and_b32 v148, 2047, v148
    v_and_b32 v149, 2047, v149
    v_and_b32 v150, 2047, v150
    v_and_b32 v151, 2047, v151
    v_cvt_f32_u32 v148, v148
    v_cvt_f32_u32 v149, v149
    v_cvt_f32_u32 v150, v150
    v_cvt_f32_u32 v151, v151
    v_mul_f32 v148, 0x3a000000, v148
    v_mul_f32 v149, 0x3a000000, v149
    v_mul_f32 v150, 0x3a000000, v150
    v_mul_f32 v151, 0x3a000000, v151
    v_cos_f32 v152, v148
    v_cos_f32 v153, v149
    v_cos_f32 v154, v150
    v_cos_f32 v155, v151
    v_sin_f32 v148, -v148
    v_sin_f32 v149, -v149
    v_sin_f32 v150, -v150
    v_sin_f32 v151, -v151
    v_cvt_pk_bf16_f32 v128, v152, v153
    v_cvt_pk_bf16_f32 v129, v154, v155
    v_cvt_pk_bf16_f32 v130, v148, v149
    v_cvt_pk_bf16_f32 v131, v150, v151
    v_add_u32 v146, 1024, v144
    v_xor_b32 v146, s58, v146
    v_add_u32 v146, s57, v146
    v_and_b32 v146, 2047, v146
    v_mul_u32_u24 v148, v146, v145
    v_add_u32 v149, v148, v146
    v_add_u32 v150, v149, v146
    v_add_u32 v151, v150, v146
    v_and_b32 v148, 2047, v148
    v_and_b32 v149, 2047, v149
    v_and_b32 v150, 2047, v150
    v_and_b32 v151, 2047, v151
    v_cvt_f32_u32 v148, v148
    v_cvt_f32_u32 v149, v149
    v_cvt_f32_u32 v150, v150
    v_cvt_f32_u32 v151, v151
    v_mul_f32 v148, 0x3a000000, v148
    v_mul_f32 v149, 0x3a000000, v149
    v_mul_f32 v150, 0x3a000000, v150
    v_mul_f32 v151, 0x3a000000, v151
    v_cos_f32 v152, v148
    v_cos_f32 v153, v149
    v_cos_f32 v154, v150
    v_cos_f32 v155, v151
    v_sin_f32 v148, -v148
    v_sin_f32 v149, -v149
    v_sin_f32 v150, -v150
    v_sin_f32 v151, -v151
    v_cvt_pk_bf16_f32 v132, v152, v153
    v_cvt_pk_bf16_f32 v133, v154, v155
    v_cvt_pk_bf16_f32 v134, v148, v149
    v_cvt_pk_bf16_f32 v135, v150, v151
    v_add_u32 v146, 32, v144
    v_xor_b32 v146, s58, v146
    v_add_u32 v146, s57, v146
    v_and_b32 v146, 2047, v146
    v_mul_u32_u24 v148, v146, v145
    v_add_u32 v149, v148, v146
    v_add_u32 v150, v149, v146
    v_add_u32 v151, v150, v146
    v_and_b32 v148, 2047, v148
    v_and_b32 v149, 2047, v149
    v_and_b32 v150, 2047, v150
    v_and_b32 v151, 2047, v151
    v_cvt_f32_u32 v148, v148
    v_cvt_f32_u32 v149, v149
    v_cvt_f32_u32 v150, v150
    v_cvt_f32_u32 v151, v151
    v_mul_f32 v148, 0x3a000000, v148
    v_mul_f32 v149, 0x3a000000, v149
    v_mul_f32 v150, 0x3a000000, v150
    v_mul_f32 v151, 0x3a000000, v151
    v_cos_f32 v152, v148
    v_cos_f32 v153, v149
    v_cos_f32 v154, v150
    v_cos_f32 v155, v151
    v_sin_f32 v148, -v148
    v_sin_f32 v149, -v149
    v_sin_f32 v150, -v150
    v_sin_f32 v151, -v151
    v_cvt_pk_bf16_f32 v136, v152, v153
    v_cvt_pk_bf16_f32 v137, v154, v155
    v_cvt_pk_bf16_f32 v138, v148, v149
    v_cvt_pk_bf16_f32 v139, v150, v151
    v_add_u32 v146, 1056, v144
    v_xor_b32 v146, s58, v146
    v_add_u32 v146, s57, v146
    v_and_b32 v146, 2047, v146
    v_mul_u32_u24 v148, v146, v145
    v_add_u32 v149, v148, v146
    v_add_u32 v150, v149, v146
    v_add_u32 v151, v150, v146
    v_and_b32 v148, 2047, v148
    v_and_b32 v149, 2047, v149
    v_and_b32 v150, 2047, v150
    v_and_b32 v151, 2047, v151
    v_cvt_f32_u32 v148, v148
    v_cvt_f32_u32 v149, v149
    v_cvt_f32_u32 v150, v150
    v_cvt_f32_u32 v151, v151
    v_mul_f32 v148, 0x3a000000, v148
    v_mul_f32 v149, 0x3a000000, v149
    v_mul_f32 v150, 0x3a000000, v150
    v_mul_f32 v151, 0x3a000000, v151
    v_cos_f32 v152, v148
    v_cos_f32 v153, v149
    v_cos_f32 v154, v150
    v_cos_f32 v155, v151
    v_sin_f32 v148, -v148
    v_sin_f32 v149, -v149
    v_sin_f32 v150, -v150
    v_sin_f32 v151, -v151
    v_cvt_pk_bf16_f32 v140, v152, v153
    v_cvt_pk_bf16_f32 v141, v154, v155
    v_cvt_pk_bf16_f32 v142, v148, v149
    v_cvt_pk_bf16_f32 v143, v150, v151
    v_mov_b32 v176, 0
    v_mov_b32 v177, 0
    v_mov_b32 v178, 0
    v_mov_b32 v179, 0
    v_mov_b32 v180, 0
    v_mov_b32 v181, 0
    v_mov_b32 v182, 0
    v_mov_b32 v183, 0
    v_mov_b32 v184, 0
    v_mov_b32 v185, 0
    v_mov_b32 v186, 0
    v_mov_b32 v187, 0
    v_mov_b32 v188, 0
    v_mov_b32 v189, 0
    v_mov_b32 v190, 0
    v_mov_b32 v191, 0
    v_mov_b32 v192, 0
    v_mov_b32 v193, 0
    v_mov_b32 v194, 0
    v_mov_b32 v195, 0
    v_mov_b32 v196, 0
    v_mov_b32 v197, 0
    v_mov_b32 v198, 0
    v_mov_b32 v199, 0
    v_mov_b32 v200, 0
    v_mov_b32 v201, 0
    v_mov_b32 v202, 0
    v_mov_b32 v203, 0
    v_mov_b32 v204, 0
    v_mov_b32 v205, 0
    v_mov_b32 v206, 0
    v_mov_b32 v207, 0
    v_mov_b32 v208, 0
    v_mov_b32 v209, 0
    v_mov_b32 v210, 0
    v_mov_b32 v211, 0
    v_mov_b32 v212, 0
    v_mov_b32 v213, 0
    v_mov_b32 v214, 0
    v_mov_b32 v215, 0
    v_mov_b32 v216, 0
    v_mov_b32 v217, 0
    v_mov_b32 v218, 0
    v_mov_b32 v219, 0
    v_mov_b32 v220, 0
    v_mov_b32 v221, 0
    v_mov_b32 v222, 0
    v_mov_b32 v223, 0
    v_mov_b32 v224, 0
    v_mov_b32 v225, 0
    v_mov_b32 v226, 0
    v_mov_b32 v227, 0
    v_mov_b32 v228, 0
    v_mov_b32 v229, 0
    v_mov_b32 v230, 0
    v_mov_b32 v231, 0
    v_mov_b32 v232, 0
    v_mov_b32 v233, 0
    v_mov_b32 v234, 0
    v_mov_b32 v235, 0
    v_mov_b32 v236, 0
    v_mov_b32 v237, 0
    v_mov_b32 v238, 0
    v_mov_b32 v239, 0
    v_mov_b32 v240, 0
    v_mov_b32 v241, 0
    v_mov_b32 v242, 0
    v_mov_b32 v243, 0
    v_mov_b32 v244, 0
    v_mov_b32 v245, 0
    v_mov_b32 v246, 0
    v_mov_b32 v247, 0
    v_mov_b32 v248, 0
    v_mov_b32 v249, 0
    v_mov_b32 v250, 0
    v_mov_b32 v251, 0
    v_mov_b32 v252, 0
    v_mov_b32 v253, 0
    v_mov_b32 v254, 0
    v_mov_b32 v255, 0
    s_waitcnt vmcnt(54)
    s_cmp_lg_u32 s49, 0
    s_cbranch_scc1 L_xi1_0
    v_lshlrev_b32 v176, 16, v160
    v_and_b32 v177, 0xffff0000, v160
    v_lshlrev_b32 v178, 16, v161
    v_and_b32 v179, 0xffff0000, v161
    v_lshlrev_b32 v192, 16, v162
    v_and_b32 v193, 0xffff0000, v162
    v_lshlrev_b32 v194, 16, v163
    v_and_b32 v195, 0xffff0000, v163
    v_lshlrev_b32 v208, 16, v164
    v_and_b32 v209, 0xffff0000, v164
    v_lshlrev_b32 v210, 16, v165
    v_and_b32 v211, 0xffff0000, v165
    v_lshlrev_b32 v224, 16, v166
    v_and_b32 v225, 0xffff0000, v166
    v_lshlrev_b32 v226, 16, v167
    v_and_b32 v227, 0xffff0000, v167
    v_lshlrev_b32 v240, 16, v168
    v_and_b32 v241, 0xffff0000, v168
    v_lshlrev_b32 v242, 16, v169
    v_and_b32 v243, 0xffff0000, v169
L_xi1_0:
    s_cmp_lg_u32 s49, 1
    s_cbranch_scc1 L_xi1_1
    v_lshlrev_b32 v180, 16, v160
    v_and_b32 v181, 0xffff0000, v160
    v_lshlrev_b32 v182, 16, v161
    v_and_b32 v183, 0xffff0000, v161
    v_lshlrev_b32 v196, 16, v162
    v_and_b32 v197, 0xffff0000, v162
    v_lshlrev_b32 v198, 16, v163
    v_and_b32 v199, 0xffff0000, v163
    v_lshlrev_b32 v212, 16, v164
    v_and_b32 v213, 0xffff0000, v164
    v_lshlrev_b32 v214, 16, v165
    v_and_b32 v215, 0xffff0000, v165
    v_lshlrev_b32 v228, 16, v166
    v_and_b32 v229, 0xffff0000, v166
    v_lshlrev_b32 v230, 16, v167
    v_and_b32 v231, 0xffff0000, v167
    v_lshlrev_b32 v244, 16, v168
    v_and_b32 v245, 0xffff0000, v168
    v_lshlrev_b32 v246, 16, v169
    v_and_b32 v247, 0xffff0000, v169
L_xi1_1:
    s_cmp_lg_u32 s49, 2
    s_cbranch_scc1 L_xi1_2
    v_lshlrev_b32 v184, 16, v160
    v_and_b32 v185, 0xffff0000, v160
    v_lshlrev_b32 v186, 16, v161
    v_and_b32 v187, 0xffff0000, v161
    v_lshlrev_b32 v200, 16, v162
    v_and_b32 v201, 0xffff0000, v162
    v_lshlrev_b32 v202, 16, v163
    v_and_b32 v203, 0xffff0000, v163
    v_lshlrev_b32 v216, 16, v164
    v_and_b32 v217, 0xffff0000, v164
    v_lshlrev_b32 v218, 16, v165
    v_and_b32 v219, 0xffff0000, v165
    v_lshlrev_b32 v232, 16, v166
    v_and_b32 v233, 0xffff0000, v166
    v_lshlrev_b32 v234, 16, v167
    v_and_b32 v235, 0xffff0000, v167
    v_lshlrev_b32 v248, 16, v168
    v_and_b32 v249, 0xffff0000, v168
    v_lshlrev_b32 v250, 16, v169
    v_and_b32 v251, 0xffff0000, v169
L_xi1_2:
    s_cmp_lg_u32 s49, 3
    s_cbranch_scc1 L_xi1_3
    v_lshlrev_b32 v188, 16, v160
    v_and_b32 v189, 0xffff0000, v160
    v_lshlrev_b32 v190, 16, v161
    v_and_b32 v191, 0xffff0000, v161
    v_lshlrev_b32 v204, 16, v162
    v_and_b32 v205, 0xffff0000, v162
    v_lshlrev_b32 v206, 16, v163
    v_and_b32 v207, 0xffff0000, v163
    v_lshlrev_b32 v220, 16, v164
    v_and_b32 v221, 0xffff0000, v164
    v_lshlrev_b32 v222, 16, v165
    v_and_b32 v223, 0xffff0000, v165
    v_lshlrev_b32 v236, 16, v166
    v_and_b32 v237, 0xffff0000, v166
    v_lshlrev_b32 v238, 16, v167
    v_and_b32 v239, 0xffff0000, v167
    v_lshlrev_b32 v252, 16, v168
    v_and_b32 v253, 0xffff0000, v168
    v_lshlrev_b32 v254, 16, v169
    v_and_b32 v255, 0xffff0000, v169
L_xi1_3:
    s_branch L_pown
L_serv:
    s_lshr_b32 s53, s2, 2
    s_and_b32 s54, s2, 3
    s_mul_i32 s51, s53, 40960
    s_mul_i32 s52, s54, 320
    s_add_u32 s51, s51, s52
    s_cmp_ge_u32 s2, 216
    s_cselect_b32 s51, 0x40000000, s51
    s_mov_b32 s56, 3277
    v_add_u32 v6, 0, v0
    v_mul_u32_u24 v7, s56, v6
    v_lshrrev_b32 v7, 16, v7
    v_mul_u32_u24 v8, 20, v7
    v_sub_u32 v6, v6, v8
    v_mul_u32_u24 v7, 1280, v7
    v_lshl_add_u32 v88, v6, 4, v7
    v_add_u32 v6, 64, v0
    v_mul_u32_u24 v7, s56, v6
    v_lshrrev_b32 v7, 16, v7
    v_mul_u32_u24 v8, 20, v7
    v_sub_u32 v6, v6, v8
    v_mul_u32_u24 v7, 1280, v7
    v_lshl_add_u32 v89, v6, 4, v7
    v_add_u32 v6, 128, v0
    v_mul_u32_u24 v7, s56, v6
    v_lshrrev_b32 v7, 16, v7
    v_mul_u32_u24 v8, 20, v7
    v_sub_u32 v6, v6, v8
    v_mul_u32_u24 v7, 1280, v7
    v_lshl_add_u32 v90, v6, 4, v7
    v_add_u32 v6, 192, v0
    v_mul_u32_u24 v7, s56, v6
    v_lshrrev_b32 v7, 16, v7
    v_mul_u32_u24 v8, 20, v7
    v_sub_u32 v6, v6, v8
    v_mul_u32_u24 v7, 1280, v7
    v_lshl_add_u32 v91, v6, 4, v7
    v_add_u32 v6, 256, v0
    v_mul_u32_u24 v7, s56, v6
    v_lshrrev_b32 v7, 16, v7
    v_mul_u32_u24 v8, 20, v7
    v_sub_u32 v6, v6, v8
    v_mul_u32_u24 v7, 1280, v7
    v_lshl_add_u32 v92, v6, 4, v7
    v_add_u32 v6, 320, v0
    v_mul_u32_u24 v7, s56, v6
    v_lshrrev_b32 v7, 16, v7
    v_mul_u32_u24 v8, 20, v7
    v_sub_u32 v6, v6, v8
    v_mul_u32_u24 v7, 1280, v7
    v_lshl_add_u32 v93, v6, 4, v7
    v_add_u32 v6, 384, v0
    v_mul_u32_u24 v7, s56, v6
    v_lshrrev_b32 v7, 16, v7
    v_mul_u32_u24 v8, 20, v7
    v_sub_u32 v6, v6, v8
    v_mul_u32_u24 v7, 1280, v7
    v_lshl_add_u32 v94, v6, 4, v7
    v_add_u32 v6, 448, v0
    v_mul_u32_u24 v7, s56, v6
    v_lshrrev_b32 v7, 16, v7
    v_mul_u32_u24 v8, 20, v7
    v_sub_u32 v6, v6, v8
    v_mul_u32_u24 v7, 1280, v7
    v_lshl_add_u32 v95, v6, 4, v7
    v_add_u32 v6, 512, v0
    v_mul_u32_u24 v7, s56, v6
    v_lshrrev_b32 v7, 16, v7
    v_mul_u32_u24 v8, 20, v7
    v_sub_u32 v6, v6, v8
    v_mul_u32_u24 v7, 1280, v7
    v_lshl_add_u32 v96, v6, 4, v7
    v_add_u32 v6, 576, v0
    v_mul_u32_u24 v7, s56, v6
    v_lshrrev_b32 v7, 16, v7
    v_mul_u32_u24 v8, 20, v7
    v_sub_u32 v6, v6, v8
    v_mul_u32_u24 v7, 1280, v7
    v_lshl_add_u32 v97, v6, 4, v7
    v_mov_b32 v60, 0x3f803f80
    v_mov_b32 v61, v60
    v_mov_b32 v62, v60
    v_mov_b32 v63, v60
    v_lshrrev_b32 v3, 4, v0
    v_bfe_u32 v6, v0, 2, 2
    v_and_b32 v7, 3, v0
    v_lshl_add_u32 v15, v3, 2, v6
    v_mul_u32_u24 v15, 320, v15
    v_lshl_add_u32 v15, v7, 3, v15
    v_add_u32 v15, 147456, v15
    s_and_b32 s57, s48, 1
    s_lshr_b32 s58, s48, 1
    s_lshl_b32 s52, s58, 13
    s_add_u32 s52, s52, 32768
    s_cmp_eq_u32 s43, 1
    s_cbranch_scc1 L_sa_d
    v_lshl_add_u32 v5, v3, 3, v6
    v_lshlrev_b32 v5, 7, v5
    v_lshl_add_u32 v5, v7, 3, v5
    v_lshrrev_b32 v6, 1, v6
    v_and_b32 v7, 1, v3
    v_lshl_add_u32 v6, v7, 1, v6
    v_lshl_add_u32 v5, v6, 5, v5
    s_lshl_b32 s57, s57, 12
    s_add_u32 s52, s52, s57
    v_add_u32 v16, s52, v5
    v_xor_b32 v17, 32, v16
    v_xor_b32 v18, 64, v16
    v_xor_b32 v19, 96, v16
    s_branch L_sa_e
L_sa_d:
    s_lshl_b32 s57, s57, 2
    v_add_u32 v7, s57, v3
    v_bfe_u32 v6, v0, 1, 3
    v_xor_b32 v7, v7, v6
    v_and_b32 v6, 15, v0
    v_lshlrev_b32 v5, 7, v6
    v_lshl_add_u32 v5, v7, 4, v5
    v_add_u32 v16, s52, v5
    v_add_u32 v17, 2048, v16
    v_add_u32 v18, 4096, v16
    v_add_u32 v19, 6144, v16
L_sa_e:
    v_lshlrev_b32 v1, 4, v0
    v_lshlrev_b32 v9, 2, v0
    v_add_u32 v9, 162304, v9
    v_mov_b32 v7, 0
    s_mov_b64 exec, 0xffff
    ds_write_b32 v9, v7
    s_mov_b64 exec, -1
    v_mov_b32 v10, 162304
    v_mov_b32 v11, 1
    v_mov_b32 v144, 0
    v_mov_b32 v145, 0
    v_mov_b32 v146, 0
    v_mov_b32 v147, 0
    v_mov_b32 v148, 0
    v_mov_b32 v149, 0
    v_mov_b32 v150, 0
    v_mov_b32 v151, 0
    v_mov_b32 v152, 0
    v_mov_b32 v153, 0
    v_mov_b32 v154, 0
    v_mov_b32 v155, 0
    v_mov_b32 v156, 0
    v_mov_b32 v157, 0
    v_mov_b32 v158, 0
    v_mov_b32 v159, 0
    s_waitcnt lgkmcnt(0)
    s_mov_b32 s16, s86
    s_and_b32 s17, s87, 0xffff
    s_mov_b32 s18, 16777216
    s_mov_b32 s19, 0x00020000
    s_mov_b32 s47, 18432
    buffer_load_dword v137, v7, s[16:19], s47 offen sc1
    s_getpc_b64 s[60:61]
L_pc:
    s_sub_u32 s60, s60, L_pc - parallel_sum__spectral_fnet__geglu_ffn__prompt_kernel
    s_subb_u32 s61, s61, 0
    s_lshr_b32 s52, s2, 3
    s_lshl_b32 s52, s52, 10
    v_lshlrev_b32 v6, 7, v0
    v_add_u32 v6, s52, v6
    v_min_u32 v6, L_end - parallel_sum__spectral_fnet__geglu_ffn__prompt_kernel, v6
    s_mov_b64 exec, 0xff
    global_load_dword v138, v6, s[60:61]
    s_mov_b64 exec, -1
    s_mov_b32 s20, s80
    s_and_b32 s21, s81, 0xffff
    s_mov_b32 s22, 2211840
    s_mov_b32 s23, 0x00020000
    v_lshlrev_b32 v1, 4, v0
    s_mul_i32 s24, s45, 276480
    s_add_u32 s24, s24, 65536
    s_mul_i32 s28, s39, 4
    s_lshr_b32 s28, s28, 2
    s_add_u32 s28, s28, s29
    s_cmp_ge_u32 s28, 6
    s_cselect_b32 s30, 6, 0
    s_sub_u32 s28, s28, s30
    s_mul_i32 s26, s49, 6
    s_add_u32 s26, s26, 30
    s_mul_i32 s25, s26, 5120
    s_add_u32 s25, s25, s24
    s_lshl_b32 s26, s26, 17
    s_lshl_b32 s27, s44, 12
    s_add_u32 s26, s26, s27
    s_add_u32 s26, s26, 4194304
    s_mov_b32 s27, s28
    s_lshl_b32 s8, s54, 6
    s_add_u32 s8, s8, s53
    s_lshl_b32 s8, s8, 7
    s_add_u32 s8, s8, 3407872
    s_lshl_b32 s11, s41, 3
    s_add_u32 s11, s11, s40
    s_lshl_b32 s11, s11, 9
    s_lshl_b32 s58, s58, 8
    s_add_u32 s11, s11, s58
    s_add_u32 s11, s11, 3145728
    v_and_b32 v173, 48, v0
    s_lshl_b32 s9, s40, 5
    s_and_b32 s52, s9, 224
    v_add_u32 v171, s52, v0
    v_add_u32 v171, 256, v171
    v_and_b32 v170, 7, v0
    v_lshlrev_b32 v170, 5, v170
    v_add_u32 v170, s41, v170
    v_cmp_gt_u32 vcc, 32, v0
    s_add_u32 s9, s9, s41
    s_lshl_b32 s9, s9, 7
    v_cndmask_b32 v171, v170, v171, vcc
    v_lshlrev_b32 v171, 7, v171
    v_min_u32 v170, 53, v0
    v_lshlrev_b32 v170, 7, v170
    s_add_u32 s13, s9, 3473408
    s_add_u32 s9, s9, 3440640
    s_lshr_b32 s10, s45, 1
    s_lshl_b32 s10, s10, 13
    s_add_u32 s10, s10, 3407872
    s_mul_i32 s12, s54, 552960
    s_mul_i32 s52, s53, 5120
    s_add_u32 s12, s12, s52
    s_add_u32 s12, s12, 65536
    s_cmp_ge_u32 s2, 216
    s_cselect_b32 s12, 0x40000000, s12
    v_mov_b32 v174, 162304
    v_mov_b32 v175, 1
    s_barrier
    s_waitcnt vmcnt(0)
    v_add_u32 v172, 1, v137
    ds_write_b32 v174, v172 offset:20
    v_readfirstlane_b32 s47, v172
    s_cmp_eq_u32 s43, 1
    s_cbranch_scc1 L_cs0_d
    ds_read_b64_tr_b16 v[64:65], v16
    ds_read_b64_tr_b16 v[66:67], v16 offset:512
    ds_read_b64_tr_b16 v[68:69], v17
    ds_read_b64_tr_b16 v[70:71], v17 offset:512
    ds_read_b64_tr_b16 v[72:73], v18
    ds_read_b64_tr_b16 v[74:75], v18 offset:512
    ds_read_b64_tr_b16 v[76:77], v19
    ds_read_b64_tr_b16 v[78:79], v19 offset:512
    s_branch L_cs0_e
L_cs0_d:
    ds_read_b128 v[64:67], v16
    ds_read_b128 v[68:71], v17
    ds_read_b128 v[72:75], v18
    ds_read_b128 v[76:79], v19
L_cs0_e:
    s_mov_b32 s52, 49152
    v_add_u32 v16, s52, v16
    v_add_u32 v17, s52, v17
    v_add_u32 v18, s52, v18
    v_add_u32 v19, s52, v19
    s_waitcnt lgkmcnt(0)
    v_mfma_f32_16x16x32_bf16 v[144:147], v[64:67], v[60:63], v[144:147]
    v_mfma_f32_16x16x32_bf16 v[148:151], v[68:71], v[60:63], v[148:151]
    v_mfma_f32_16x16x32_bf16 v[152:155], v[72:75], v[60:63], v[152:155]
    v_mfma_f32_16x16x32_bf16 v[156:159], v[76:79], v[60:63], v[156:159]
    s_barrier
    s_waitcnt vmcnt(0)
    s_mov_b64 exec, 1
    buffer_store_dword v172, v7, s[16:19], s13 offen sc1
    s_mov_b64 exec, -1
    s_cmp_eq_u32 s43, 1
    s_cbranch_scc1 L_cs1_d
    ds_read_b64_tr_b16 v[64:65], v16
    ds_read_b64_tr_b16 v[66:67], v16 offset:512
    ds_read_b64_tr_b16 v[68:69], v17
    ds_read_b64_tr_b16 v[70:71], v17 offset:512
    ds_read_b64_tr_b16 v[72:73], v18
    ds_read_b64_tr_b16 v[74:75], v18 offset:512
    ds_read_b64_tr_b16 v[76:77], v19
    ds_read_b64_tr_b16 v[78:79], v19 offset:512
    s_branch L_cs1_e
L_cs1_d:
    ds_read_b128 v[64:67], v16
    ds_read_b128 v[68:71], v17
    ds_read_b128 v[72:75], v18
    ds_read_b128 v[76:79], v19
L_cs1_e:
    s_mov_b32 s52, 49152
    v_add_u32 v16, s52, v16
    v_add_u32 v17, s52, v17
    v_add_u32 v18, s52, v18
    v_add_u32 v19, s52, v19
    s_waitcnt lgkmcnt(0)
    v_mfma_f32_16x16x32_bf16 v[144:147], v[64:67], v[60:63], v[144:147]
    v_mfma_f32_16x16x32_bf16 v[148:151], v[68:71], v[60:63], v[148:151]
    v_mfma_f32_16x16x32_bf16 v[152:155], v[72:75], v[60:63], v[152:155]
    v_mfma_f32_16x16x32_bf16 v[156:159], v[76:79], v[60:63], v[156:159]
    s_mov_b32 m0, 147456
    s_nop 0
    buffer_load_dwordx4 v88, s[20:23], s51 offen nt lds
    s_mov_b32 m0, 148480
    s_nop 0
    buffer_load_dwordx4 v89, s[20:23], s51 offen nt lds
    s_mov_b32 m0, 149504
    s_nop 0
    buffer_load_dwordx4 v90, s[20:23], s51 offen nt lds
    s_mov_b32 m0, 150528
    s_nop 0
    buffer_load_dwordx4 v91, s[20:23], s51 offen nt lds
    s_mov_b32 m0, 151552
    s_nop 0
    buffer_load_dwordx4 v92, s[20:23], s51 offen nt lds
    s_mov_b32 m0, 152576
    s_nop 0
    buffer_load_dwordx4 v93, s[20:23], s51 offen nt lds
    s_mov_b32 m0, 153600
    s_nop 0
    buffer_load_dwordx4 v94, s[20:23], s51 offen nt lds
    s_mov_b32 m0, 154624
    s_nop 0
    buffer_load_dwordx4 v95, s[20:23], s51 offen nt lds
    s_mov_b32 m0, 155648
    s_nop 0
    buffer_load_dwordx4 v96, s[20:23], s51 offen nt lds
    s_mov_b32 m0, 156672
    s_nop 0
    buffer_load_dwordx4 v97, s[20:23], s51 offen nt lds
    s_barrier
    s_cmp_eq_u32 s43, 1
    s_cbranch_scc1 L_cs2_d
    ds_read_b64_tr_b16 v[64:65], v16
    ds_read_b64_tr_b16 v[66:67], v16 offset:512
    ds_read_b64_tr_b16 v[68:69], v17
    ds_read_b64_tr_b16 v[70:71], v17 offset:512
    ds_read_b64_tr_b16 v[72:73], v18
    ds_read_b64_tr_b16 v[74:75], v18 offset:512
    ds_read_b64_tr_b16 v[76:77], v19
    ds_read_b64_tr_b16 v[78:79], v19 offset:512
    s_branch L_cs2_e
L_cs2_d:
    ds_read_b128 v[64:67], v16
    ds_read_b128 v[68:71], v17
    ds_read_b128 v[72:75], v18
    ds_read_b128 v[76:79], v19
L_cs2_e:
    s_mov_b32 s52, -98304
    v_add_u32 v16, s52, v16
    v_add_u32 v17, s52, v17
    v_add_u32 v18, s52, v18
    v_add_u32 v19, s52, v19
    s_waitcnt lgkmcnt(0)
    v_mfma_f32_16x16x32_bf16 v[144:147], v[64:67], v[60:63], v[144:147]
    v_mfma_f32_16x16x32_bf16 v[148:151], v[68:71], v[60:63], v[148:151]
    v_mfma_f32_16x16x32_bf16 v[152:155], v[72:75], v[60:63], v[152:155]
    v_mfma_f32_16x16x32_bf16 v[156:159], v[76:79], v[60:63], v[156:159]
    s_barrier
    s_cmp_eq_u32 s43, 1
    s_cbranch_scc1 L_cs3_d
    ds_read_b64_tr_b16 v[64:65], v16
    ds_read_b64_tr_b16 v[66:67], v16 offset:512
    ds_read_b64_tr_b16 v[68:69], v17
    ds_read_b64_tr_b16 v[70:71], v17 offset:512
    ds_read_b64_tr_b16 v[72:73], v18
    ds_read_b64_tr_b16 v[74:75], v18 offset:512
    ds_read_b64_tr_b16 v[76:77], v19
    ds_read_b64_tr_b16 v[78:79], v19 offset:512
    s_branch L_cs3_e
L_cs3_d:
    ds_read_b128 v[64:67], v16
    ds_read_b128 v[68:71], v17
    ds_read_b128 v[72:75], v18
    ds_read_b128 v[76:79], v19
L_cs3_e:
    s_mov_b32 s52, 49152
    v_add_u32 v16, s52, v16
    v_add_u32 v17, s52, v17
    v_add_u32 v18, s52, v18
    v_add_u32 v19, s52, v19
    s_waitcnt lgkmcnt(0)
    v_mfma_f32_16x16x32_bf16 v[144:147], v[64:67], v[60:63], v[144:147]
    v_mfma_f32_16x16x32_bf16 v[148:151], v[68:71], v[60:63], v[148:151]
    v_mfma_f32_16x16x32_bf16 v[152:155], v[72:75], v[60:63], v[152:155]
    v_mfma_f32_16x16x32_bf16 v[156:159], v[76:79], v[60:63], v[156:159]
    s_waitcnt vmcnt(0)
    ds_read_b64_tr_b16 v[88:89], v15 offset:0
    ds_read_b64_tr_b16 v[90:91], v15 offset:5120
    ds_read_b64_tr_b16 v[92:93], v15 offset:32
    ds_read_b64_tr_b16 v[94:95], v15 offset:5152
    ds_read_b64_tr_b16 v[96:97], v15 offset:64
    ds_read_b64_tr_b16 v[98:99], v15 offset:5184
    ds_read_b64_tr_b16 v[100:101], v15 offset:96
    ds_read_b64_tr_b16 v[102:103], v15 offset:5216
    ds_read_b64_tr_b16 v[104:105], v15 offset:128
    ds_read_b64_tr_b16 v[106:107], v15 offset:5248
    ds_read_b64_tr_b16 v[108:109], v15 offset:160
    ds_read_b64_tr_b16 v[110:111], v15 offset:5280
    ds_read_b64_tr_b16 v[112:113], v15 offset:192
    ds_read_b64_tr_b16 v[114:115], v15 offset:5312
    ds_read_b64_tr_b16 v[116:117], v15 offset:224
    ds_read_b64_tr_b16 v[118:119], v15 offset:5344
    ds_read_b64_tr_b16 v[120:121], v15 offset:256
    ds_read_b64_tr_b16 v[122:123], v15 offset:5376
    ds_read_b64_tr_b16 v[124:125], v15 offset:288
    ds_read_b64_tr_b16 v[126:127], v15 offset:5408
    s_waitcnt lgkmcnt(0)
    s_add_u32 s52, s12, 0
    buffer_store_dwordx4 v[88:91], v1, s[16:19], s52 offen offset:0 sc1
    s_add_u32 s52, s12, 0
    buffer_store_dwordx4 v[92:95], v1, s[16:19], s52 offen offset:1024 sc1
    s_add_u32 s52, s12, 0
    buffer_store_dwordx4 v[96:99], v1, s[16:19], s52 offen offset:2048 sc1
    s_add_u32 s52, s12, 0
    buffer_store_dwordx4 v[100:103], v1, s[16:19], s52 offen offset:3072 sc1
    s_add_u32 s52, s12, 4096
    buffer_store_dwordx4 v[104:107], v1, s[16:19], s52 offen offset:0 sc1
    s_add_u32 s52, s12, 276480
    buffer_store_dwordx4 v[108:111], v1, s[16:19], s52 offen offset:0 sc1
    s_add_u32 s52, s12, 276480
    buffer_store_dwordx4 v[112:115], v1, s[16:19], s52 offen offset:1024 sc1
    s_add_u32 s52, s12, 276480
    buffer_store_dwordx4 v[116:119], v1, s[16:19], s52 offen offset:2048 sc1
    s_add_u32 s52, s12, 276480
    buffer_store_dwordx4 v[120:123], v1, s[16:19], s52 offen offset:3072 sc1
    s_add_u32 s52, s12, 280576
    buffer_store_dwordx4 v[124:127], v1, s[16:19], s52 offen offset:0 sc1
    s_barrier
    s_cmp_eq_u32 s43, 1
    s_cbranch_scc1 L_cs4_d
    ds_read_b64_tr_b16 v[64:65], v16
    ds_read_b64_tr_b16 v[66:67], v16 offset:512
    ds_read_b64_tr_b16 v[68:69], v17
    ds_read_b64_tr_b16 v[70:71], v17 offset:512
    ds_read_b64_tr_b16 v[72:73], v18
    ds_read_b64_tr_b16 v[74:75], v18 offset:512
    ds_read_b64_tr_b16 v[76:77], v19
    ds_read_b64_tr_b16 v[78:79], v19 offset:512
    s_branch L_cs4_e
L_cs4_d:
    ds_read_b128 v[64:67], v16
    ds_read_b128 v[68:71], v17
    ds_read_b128 v[72:75], v18
    ds_read_b128 v[76:79], v19
L_cs4_e:
    s_mov_b32 s52, 49152
    v_add_u32 v16, s52, v16
    v_add_u32 v17, s52, v17
    v_add_u32 v18, s52, v18
    v_add_u32 v19, s52, v19
    s_waitcnt lgkmcnt(0)
    v_mfma_f32_16x16x32_bf16 v[144:147], v[64:67], v[60:63], v[144:147]
    v_mfma_f32_16x16x32_bf16 v[148:151], v[68:71], v[60:63], v[148:151]
    v_mfma_f32_16x16x32_bf16 v[152:155], v[72:75], v[60:63], v[152:155]
    v_mfma_f32_16x16x32_bf16 v[156:159], v[76:79], v[60:63], v[156:159]
    s_waitcnt vmcnt(0)
    s_mov_b64 exec, 1
    buffer_store_dword v172, v7, s[16:19], s8 offen sc1
    s_mov_b64 exec, -1
    s_nop 7
    s_mov_b32 exec_lo, 0x00010001
    s_mov_b32 exec_hi, 0x00010001
    buffer_store_dwordx4 v[144:147], v173, s[16:19], s11 offen offset:0 sc1
    buffer_store_dwordx4 v[148:151], v173, s[16:19], s11 offen offset:64 sc1
    buffer_store_dwordx4 v[152:155], v173, s[16:19], s11 offen offset:128 sc1
    buffer_store_dwordx4 v[156:159], v173, s[16:19], s11 offen offset:192 sc1
    s_mov_b64 exec, -1
    s_barrier
    s_waitcnt vmcnt(0)
    s_mov_b64 exec, 1
    buffer_store_dword v172, v7, s[16:19], s9 offen sc1
    s_mov_b64 exec, -1
    s_barrier
    s_mov_b32 s51, s10
    s_barrier
    s_mov_b32 s50, 3440640
    buffer_load_dword v5, v170, s[16:19], s51 offen sc1
    buffer_load_dword v6, v171, s[16:19], s50 offen sc1
    s_barrier
    s_waitcnt vmcnt(0)
    v_cmp_ne_u32 s[58:59], s47, v5
    v_cmp_ne_u32 vcc, s47, v6
    s_cbranch_vccz L_p3d
    s_cmp_lg_u64 s[58:59], 0
    s_cbranch_scc1 L_p3w
    ds_write_b32 v174, v175 offset:16
L_p3w:
    s_mov_b32 s60, 0
L_p3:
    buffer_load_dword v6, v171, s[16:19], s50 offen sc1
    s_add_u32 s60, s60, 1
    s_waitcnt vmcnt(0)
    v_cmp_ne_u32 vcc, s47, v6
    s_cbranch_vccz L_p3d
    s_sleep 3
    s_cmp_lt_u32 s60, 0x40000
    s_cbranch_scc1 L_p3
L_p3d:
    v_lshlrev_b32 v6, 3, v0
    v_lshrrev_b32 v5, 5, v0
    v_lshl_add_u32 v5, v5, 10, v6
    s_lshl_b32 s50, s40, 11
    s_lshl_b32 s52, s41, 12
    s_add_u32 s52, s52, 3145728
    buffer_load_dwordx2 v[128:129], v6, s[16:19], s50 offen offset:0 sc1
    buffer_load_dwordx2 v[132:133], v6, s[16:19], s50 offen offset:512 sc1
    buffer_load_dwordx2 v[136:137], v6, s[16:19], s50 offen offset:1024 sc1
    buffer_load_dwordx2 v[140:141], v6, s[16:19], s50 offen offset:1536 sc1
    buffer_load_dwordx2 v[144:145], v5, s[16:19], s52 offen offset:0 sc1
    buffer_load_dwordx2 v[146:147], v5, s[16:19], s52 offen offset:512 sc1
    buffer_load_dwordx2 v[148:149], v5, s[16:19], s52 offen offset:2048 sc1
    buffer_load_dwordx2 v[150:151], v5, s[16:19], s52 offen offset:2560 sc1
    s_cmp_eq_u64 s[58:59], 0
    s_cbranch_scc1 L_p1d
    s_mov_b32 s60, 0
L_p1:
    buffer_load_dword v5, v170, s[16:19], s51 offen sc1
    s_add_u32 s60, s60, 1
    s_waitcnt vmcnt(0)
    v_cmp_ne_u32 vcc, s47, v5
    s_cbranch_vccz L_p1d
    s_sleep 3
    s_cmp_lt_u32 s60, 0x40000
    s_cbranch_scc1 L_p1
L_p1d:
    ds_write_b32 v174, v175 offset:16
    s_waitcnt vmcnt(0)
    v_rsq_f32 v152, v129
    v_rsq_f32 v153, v133
    v_rsq_f32 v154, v137
    v_rsq_f32 v155, v141
    v_add_f32 v144, v144, v146
    v_add_f32 v145, v145, v147
    v_add_f32 v144, v144, v148
    v_add_f32 v145, v145, v149
    v_add_f32 v144, v144, v150
    v_add_f32 v145, v145, v151
    v_add_u32 v6, 161792, v6
    ds_write_b64 v6, v[144:145]
    s_cmp_eq_u32 s43, 1
    s_cbranch_scc1 L_serv_cdft
    v_add_u32 v6, 157696, v1
    v_mov_b32 v131, v129
    v_mul_f32 v156, v152, v152
    v_xor_b32 v128, 0x80000000, v128
    v_mul_f32 v129, 0xc0135761, v152
    v_mul_f32 v156, v156, v152
    v_mul_f32 v130, 0xbdd2d3e8, v156
    ds_write_b128 v6, v[128:131] offset:0
    v_mov_b32 v135, v133
    v_mul_f32 v156, v153, v153
    v_xor_b32 v132, 0x80000000, v132
    v_mul_f32 v133, 0xc0135761, v153
    v_mul_f32 v156, v156, v153
    v_mul_f32 v134, 0xbdd2d3e8, v156
    ds_write_b128 v6, v[132:135] offset:1024
    v_mov_b32 v139, v137
    v_mul_f32 v156, v154, v154
    v_xor_b32 v136, 0x80000000, v136
    v_mul_f32 v137, 0xc0135761, v154
    v_mul_f32 v156, v156, v154
    v_mul_f32 v138, 0xbdd2d3e8, v156
    ds_write_b128 v6, v[136:139] offset:2048
    v_mov_b32 v143, v141
    v_mul_f32 v156, v155, v155
    v_xor_b32 v140, 0x80000000, v140
    v_mul_f32 v141, 0xc0135761, v155
    v_mul_f32 v156, v156, v155
    v_mul_f32 v142, 0xbdd2d3e8, v156
    ds_write_b128 v6, v[140:143] offset:3072
    s_branch L_serv_cd
L_serv_cdft:
    v_lshlrev_b32 v6, 2, v0
    v_add_u32 v6, 157696, v6
    v_mul_f32 v128, v128, v152
    v_xor_b32 v128, 0x80000000, v128
    ds_write_b32 v6, v152 offset:0
    ds_write_b32 v6, v128 offset:1024
    v_mul_f32 v132, v132, v153
    v_xor_b32 v132, 0x80000000, v132
    ds_write_b32 v6, v153 offset:256
    ds_write_b32 v6, v132 offset:1280
    v_mul_f32 v136, v136, v154
    v_xor_b32 v136, 0x80000000, v136
    ds_write_b32 v6, v154 offset:512
    ds_write_b32 v6, v136 offset:1536
    v_mul_f32 v140, v140, v155
    v_xor_b32 v140, 0x80000000, v140
    ds_write_b32 v6, v155 offset:768
    ds_write_b32 v6, v140 offset:1792
L_serv_cd:
    ds_write_b32 v174, v175 offset:8
    s_waitcnt lgkmcnt(0)
    s_mov_b32 s4, s64
    s_and_b32 s5, s65, 0xffff
    s_mov_b32 s6, 2621440
    s_mov_b32 s7, 0x00020000
    v_and_b32 v2, 15, v0
    v_lshlrev_b32 v2, 6, v2
    v_add_u32 v2, s44, v2
    v_mul_u32_u24 v2, 1280, v2
    v_lshrrev_b32 v3, 4, v0
    v_lshl_add_u32 v2, v3, 3, v2
    s_and_b32 s30, s49, 1
    s_mul_i32 s30, s30, 1310720
    s_lshr_b32 s31, s49, 1
    s_mul_i32 s31, s31, 40960
    s_add_u32 s30, s30, s31
    s_mul_i32 s31, s45, 160
    s_add_u32 s30, s30, s31
    buffer_load_dwordx2 v[160:161], v2, s[4:7], s30 offen offset:0
    buffer_load_dwordx2 v[162:163], v2, s[4:7], s30 offen offset:32
    buffer_load_dwordx2 v[164:165], v2, s[4:7], s30 offen offset:64
    buffer_load_dwordx2 v[166:167], v2, s[4:7], s30 offen offset:96
    buffer_load_dwordx2 v[168:169], v2, s[4:7], s30 offen offset:128
    s_mul_i32 s30, s27, 5120
    s_add_u32 s30, s30, s25
    s_add_u32 s31, s30, 4096
    buffer_load_dwordx4 v[8:11], v1, s[16:19], s30 offen offset:0 sc1
    buffer_load_dwordx4 v[12:15], v1, s[16:19], s30 offen offset:1024 sc1
    buffer_load_dwordx4 v[16:19], v1, s[16:19], s30 offen offset:2048 sc1
    buffer_load_dwordx4 v[20:23], v1, s[16:19], s30 offen offset:3072 sc1
    buffer_load_dwordx4 v[24:27], v1, s[16:19], s31 offen sc1
    s_add_u32 s27, s27, 1
    s_cmp_eq_u32 s27, 6
    s_cselect_b32 s27, 0, s27
    s_mul_i32 s30, s27, 5120
    s_add_u32 s30, s30, s25
    s_add_u32 s31, s30, 4096
    buffer_load_dwordx4 v[28:31], v1, s[16:19], s30 offen offset:0 sc1
    buffer_load_dwordx4 v[32:35], v1, s[16:19], s30 offen offset:1024 sc1
    buffer_load_dwordx4 v[36:39], v1, s[16:19], s30 offen offset:2048 sc1
    buffer_load_dwordx4 v[40:43], v1, s[16:19], s30 offen offset:3072 sc1
    buffer_load_dwordx4 v[44:47], v1, s[16:19], s31 offen sc1
    s_add_u32 s27, s27, 1
    s_cmp_eq_u32 s27, 6
    s_cselect_b32 s27, 0, s27
    s_setprio 0
    s_cmp_ge_u32 s45, 4
    s_cselect_b32 s58, -1, 0
    s_and_b32 s57, s58, 1
    v_and_b32 v2, 15, v0
    v_lshlrev_b32 v144, 6, v2
    v_add_u32 v144, s44, v144
    v_lshrrev_b32 v3, 4, v0
    s_lshl_b32 s52, s49, 4
    v_lshl_add_u32 v145, v3, 2, s52
    v_add_u32 v146, 0, v144
    v_xor_b32 v146, s58, v146
    v_add_u32 v146, s57, v146
    v_and_b32 v146, 2047, v146
    v_mul_u32_u24 v148, v146, v145
    v_add_u32 v149, v148, v146
    v_add_u32 v150, v149, v146
    v_add_u32 v151, v150, v146
    v_and_b32 v148, 2047, v148
    v_and_b32 v149, 2047, v149
    v_and_b32 v150, 2047, v150
    v_and_b32 v151, 2047, v151
    v_cvt_f32_u32 v148, v148
    v_cvt_f32_u32 v149, v149
    v_cvt_f32_u32 v150, v150
    v_cvt_f32_u32 v151, v151
    v_mul_f32 v148, 0x3a000000, v148
    v_mul_f32 v149, 0x3a000000, v149
    v_mul_f32 v150, 0x3a000000, v150
    v_mul_f32 v151, 0x3a000000, v151
    v_cos_f32 v152, v148
    v_cos_f32 v153, v149
    v_cos_f32 v154, v150
    v_cos_f32 v155, v151
    v_sin_f32 v148, -v148
    v_sin_f32 v149, -v149
    v_sin_f32 v150, -v150
    v_sin_f32 v151, -v151
    v_cvt_pk_bf16_f32 v128, v152, v153
    v_cvt_pk_bf16_f32 v129, v154, v155
    v_cvt_pk_bf16_f32 v130, v148, v149
    v_cvt_pk_bf16_f32 v131, v150, v151
    v_add_u32 v146, 1024, v144
    v_xor_b32 v146, s58, v146
    v_add_u32 v146, s57, v146
    v_and_b32 v146, 2047, v146
    v_mul_u32_u24 v148, v146, v145
    v_add_u32 v149, v148, v146
    v_add_u32 v150, v149, v146
    v_add_u32 v151, v150, v146
    v_and_b32 v148, 2047, v148
    v_and_b32 v149, 2047, v149
    v_and_b32 v150, 2047, v150
    v_and_b32 v151, 2047, v151
    v_cvt_f32_u32 v148, v148
    v_cvt_f32_u32 v149, v149
    v_cvt_f32_u32 v150, v150
    v_cvt_f32_u32 v151, v151
    v_mul_f32 v148, 0x3a000000, v148
    v_mul_f32 v149, 0x3a000000, v149
    v_mul_f32 v150, 0x3a000000, v150
    v_mul_f32 v151, 0x3a000000, v151
    v_cos_f32 v152, v148
    v_cos_f32 v153, v149
    v_cos_f32 v154, v150
    v_cos_f32 v155, v151
    v_sin_f32 v148, -v148
    v_sin_f32 v149, -v149
    v_sin_f32 v150, -v150
    v_sin_f32 v151, -v151
    v_cvt_pk_bf16_f32 v132, v152, v153
    v_cvt_pk_bf16_f32 v133, v154, v155
    v_cvt_pk_bf16_f32 v134, v148, v149
    v_cvt_pk_bf16_f32 v135, v150, v151
    v_add_u32 v146, 32, v144
    v_xor_b32 v146, s58, v146
    v_add_u32 v146, s57, v146
    v_and_b32 v146, 2047, v146
    v_mul_u32_u24 v148, v146, v145
    v_add_u32 v149, v148, v146
    v_add_u32 v150, v149, v146
    v_add_u32 v151, v150, v146
    v_and_b32 v148, 2047, v148
    v_and_b32 v149, 2047, v149
    v_and_b32 v150, 2047, v150
    v_and_b32 v151, 2047, v151
    v_cvt_f32_u32 v148, v148
    v_cvt_f32_u32 v149, v149
    v_cvt_f32_u32 v150, v150
    v_cvt_f32_u32 v151, v151
    v_mul_f32 v148, 0x3a000000, v148
    v_mul_f32 v149, 0x3a000000, v149
    v_mul_f32 v150, 0x3a000000, v150
    v_mul_f32 v151, 0x3a000000, v151
    v_cos_f32 v152, v148
    v_cos_f32 v153, v149
    v_cos_f32 v154, v150
    v_cos_f32 v155, v151
    v_sin_f32 v148, -v148
    v_sin_f32 v149, -v149
    v_sin_f32 v150, -v150
    v_sin_f32 v151, -v151
    v_cvt_pk_bf16_f32 v136, v152, v153
    v_cvt_pk_bf16_f32 v137, v154, v155
    v_cvt_pk_bf16_f32 v138, v148, v149
    v_cvt_pk_bf16_f32 v139, v150, v151
    v_add_u32 v146, 1056, v144
    v_xor_b32 v146, s58, v146
    v_add_u32 v146, s57, v146
    v_and_b32 v146, 2047, v146
    v_mul_u32_u24 v148, v146, v145
    v_add_u32 v149, v148, v146
    v_add_u32 v150, v149, v146
    v_add_u32 v151, v150, v146
    v_and_b32 v148, 2047, v148
    v_and_b32 v149, 2047, v149
    v_and_b32 v150, 2047, v150
    v_and_b32 v151, 2047, v151
    v_cvt_f32_u32 v148, v148
    v_cvt_f32_u32 v149, v149
    v_cvt_f32_u32 v150, v150
    v_cvt_f32_u32 v151, v151
    v_mul_f32 v148, 0x3a000000, v148
    v_mul_f32 v149, 0x3a000000, v149
    v_mul_f32 v150, 0x3a000000, v150
    v_mul_f32 v151, 0x3a000000, v151
    v_cos_f32 v152, v148
    v_cos_f32 v153, v149
    v_cos_f32 v154, v150
    v_cos_f32 v155, v151
    v_sin_f32 v148, -v148
    v_sin_f32 v149, -v149
    v_sin_f32 v150, -v150
    v_sin_f32 v151, -v151
    v_cvt_pk_bf16_f32 v140, v152, v153
    v_cvt_pk_bf16_f32 v141, v154, v155
    v_cvt_pk_bf16_f32 v142, v148, v149
    v_cvt_pk_bf16_f32 v143, v150, v151
    v_mov_b32 v176, 0
    v_mov_b32 v177, 0
    v_mov_b32 v178, 0
    v_mov_b32 v179, 0
    v_mov_b32 v180, 0
    v_mov_b32 v181, 0
    v_mov_b32 v182, 0
    v_mov_b32 v183, 0
    v_mov_b32 v184, 0
    v_mov_b32 v185, 0
    v_mov_b32 v186, 0
    v_mov_b32 v187, 0
    v_mov_b32 v188, 0
    v_mov_b32 v189, 0
    v_mov_b32 v190, 0
    v_mov_b32 v191, 0
    v_mov_b32 v192, 0
    v_mov_b32 v193, 0
    v_mov_b32 v194, 0
    v_mov_b32 v195, 0
    v_mov_b32 v196, 0
    v_mov_b32 v197, 0
    v_mov_b32 v198, 0
    v_mov_b32 v199, 0
    v_mov_b32 v200, 0
    v_mov_b32 v201, 0
    v_mov_b32 v202, 0
    v_mov_b32 v203, 0
    v_mov_b32 v204, 0
    v_mov_b32 v205, 0
    v_mov_b32 v206, 0
    v_mov_b32 v207, 0
    v_mov_b32 v208, 0
    v_mov_b32 v209, 0
    v_mov_b32 v210, 0
    v_mov_b32 v211, 0
    v_mov_b32 v212, 0
    v_mov_b32 v213, 0
    v_mov_b32 v214, 0
    v_mov_b32 v215, 0
    v_mov_b32 v216, 0
    v_mov_b32 v217, 0
    v_mov_b32 v218, 0
    v_mov_b32 v219, 0
    v_mov_b32 v220, 0
    v_mov_b32 v221, 0
    v_mov_b32 v222, 0
    v_mov_b32 v223, 0
    v_mov_b32 v224, 0
    v_mov_b32 v225, 0
    v_mov_b32 v226, 0
    v_mov_b32 v227, 0
    v_mov_b32 v228, 0
    v_mov_b32 v229, 0
    v_mov_b32 v230, 0
    v_mov_b32 v231, 0
    v_mov_b32 v232, 0
    v_mov_b32 v233, 0
    v_mov_b32 v234, 0
    v_mov_b32 v235, 0
    v_mov_b32 v236, 0
    v_mov_b32 v237, 0
    v_mov_b32 v238, 0
    v_mov_b32 v239, 0
    v_mov_b32 v240, 0
    v_mov_b32 v241, 0
    v_mov_b32 v242, 0
    v_mov_b32 v243, 0
    v_mov_b32 v244, 0
    v_mov_b32 v245, 0
    v_mov_b32 v246, 0
    v_mov_b32 v247, 0
    v_mov_b32 v248, 0
    v_mov_b32 v249, 0
    v_mov_b32 v250, 0
    v_mov_b32 v251, 0
    v_mov_b32 v252, 0
    v_mov_b32 v253, 0
    v_mov_b32 v254, 0
    v_mov_b32 v255, 0
    s_waitcnt vmcnt(10)
    s_cmp_lg_u32 s49, 0
    s_cbranch_scc1 L_xi2_0
    v_lshlrev_b32 v176, 16, v160
    v_and_b32 v177, 0xffff0000, v160
    v_lshlrev_b32 v178, 16, v161
    v_and_b32 v179, 0xffff0000, v161
    v_lshlrev_b32 v192, 16, v162
    v_and_b32 v193, 0xffff0000, v162
    v_lshlrev_b32 v194, 16, v163
    v_and_b32 v195, 0xffff0000, v163
    v_lshlrev_b32 v208, 16, v164
    v_and_b32 v209, 0xffff0000, v164
    v_lshlrev_b32 v210, 16, v165
    v_and_b32 v211, 0xffff0000, v165
    v_lshlrev_b32 v224, 16, v166
    v_and_b32 v225, 0xffff0000, v166
    v_lshlrev_b32 v226, 16, v167
    v_and_b32 v227, 0xffff0000, v167
    v_lshlrev_b32 v240, 16, v168
    v_and_b32 v241, 0xffff0000, v168
    v_lshlrev_b32 v242, 16, v169
    v_and_b32 v243, 0xffff0000, v169
L_xi2_0:
    s_cmp_lg_u32 s49, 1
    s_cbranch_scc1 L_xi2_1
    v_lshlrev_b32 v180, 16, v160
    v_and_b32 v181, 0xffff0000, v160
    v_lshlrev_b32 v182, 16, v161
    v_and_b32 v183, 0xffff0000, v161
    v_lshlrev_b32 v196, 16, v162
    v_and_b32 v197, 0xffff0000, v162
    v_lshlrev_b32 v198, 16, v163
    v_and_b32 v199, 0xffff0000, v163
    v_lshlrev_b32 v212, 16, v164
    v_and_b32 v213, 0xffff0000, v164
    v_lshlrev_b32 v214, 16, v165
    v_and_b32 v215, 0xffff0000, v165
    v_lshlrev_b32 v228, 16, v166
    v_and_b32 v229, 0xffff0000, v166
    v_lshlrev_b32 v230, 16, v167
    v_and_b32 v231, 0xffff0000, v167
    v_lshlrev_b32 v244, 16, v168
    v_and_b32 v245, 0xffff0000, v168
    v_lshlrev_b32 v246, 16, v169
    v_and_b32 v247, 0xffff0000, v169
L_xi2_1:
    s_cmp_lg_u32 s49, 2
    s_cbranch_scc1 L_xi2_2
    v_lshlrev_b32 v184, 16, v160
    v_and_b32 v185, 0xffff0000, v160
    v_lshlrev_b32 v186, 16, v161
    v_and_b32 v187, 0xffff0000, v161
    v_lshlrev_b32 v200, 16, v162
    v_and_b32 v201, 0xffff0000, v162
    v_lshlrev_b32 v202, 16, v163
    v_and_b32 v203, 0xffff0000, v163
    v_lshlrev_b32 v216, 16, v164
    v_and_b32 v217, 0xffff0000, v164
    v_lshlrev_b32 v218, 16, v165
    v_and_b32 v219, 0xffff0000, v165
    v_lshlrev_b32 v232, 16, v166
    v_and_b32 v233, 0xffff0000, v166
    v_lshlrev_b32 v234, 16, v167
    v_and_b32 v235, 0xffff0000, v167
    v_lshlrev_b32 v248, 16, v168
    v_and_b32 v249, 0xffff0000, v168
    v_lshlrev_b32 v250, 16, v169
    v_and_b32 v251, 0xffff0000, v169
L_xi2_2:
    s_cmp_lg_u32 s49, 3
    s_cbranch_scc1 L_xi2_3
    v_lshlrev_b32 v188, 16, v160
    v_and_b32 v189, 0xffff0000, v160
    v_lshlrev_b32 v190, 16, v161
    v_and_b32 v191, 0xffff0000, v161
    v_lshlrev_b32 v204, 16, v162
    v_and_b32 v205, 0xffff0000, v162
    v_lshlrev_b32 v206, 16, v163
    v_and_b32 v207, 0xffff0000, v163
    v_lshlrev_b32 v220, 16, v164
    v_and_b32 v221, 0xffff0000, v164
    v_lshlrev_b32 v222, 16, v165
    v_and_b32 v223, 0xffff0000, v165
    v_lshlrev_b32 v236, 16, v166
    v_and_b32 v237, 0xffff0000, v166
    v_lshlrev_b32 v238, 16, v167
    v_and_b32 v239, 0xffff0000, v167
    v_lshlrev_b32 v252, 16, v168
    v_and_b32 v253, 0xffff0000, v168
    v_lshlrev_b32 v254, 16, v169
    v_and_b32 v255, 0xffff0000, v169
L_xi2_3:
    s_waitcnt vmcnt(4)
    s_mul_i32 s30, s27, 5120
    s_add_u32 s30, s30, s25
    s_add_u32 s31, s30, 4096
    buffer_load_dwordx4 v[48:51], v1, s[16:19], s30 offen offset:0 sc1
    buffer_load_dwordx4 v[52:55], v1, s[16:19], s30 offen offset:1024 sc1
    buffer_load_dwordx4 v[56:59], v1, s[16:19], s30 offen offset:2048 sc1
    buffer_load_dwordx4 v[60:63], v1, s[16:19], s30 offen offset:3072 sc1
    buffer_load_dwordx4 v[64:67], v1, s[16:19], s31 offen sc1
    s_add_u32 s27, s27, 1
    s_cmp_eq_u32 s27, 6
    s_cselect_b32 s27, 0, s27
    s_waitcnt vmcnt(4)
    s_mul_i32 s30, s27, 5120
    s_add_u32 s30, s30, s25
    s_add_u32 s31, s30, 4096
    buffer_load_dwordx4 v[68:71], v1, s[16:19], s30 offen offset:0 sc1
    buffer_load_dwordx4 v[72:75], v1, s[16:19], s30 offen offset:1024 sc1
    buffer_load_dwordx4 v[76:79], v1, s[16:19], s30 offen offset:2048 sc1
    buffer_load_dwordx4 v[80:83], v1, s[16:19], s30 offen offset:3072 sc1
    buffer_load_dwordx4 v[84:87], v1, s[16:19], s31 offen sc1
    s_add_u32 s27, s27, 1
    s_cmp_eq_u32 s27, 6
    s_cselect_b32 s27, 0, s27
    s_cmp_eq_u32 s43, 1
    s_cbranch_scc1 L_spdd
    v_mov_b32 v144, 162304
    s_mov_b32 s60, 0
L_spd:
    ds_read_b32 v145, v144
    s_add_u32 s60, s60, 1
    s_waitcnt lgkmcnt(0)
    v_cmp_gt_u32 vcc, 4, v145
    s_cbranch_vccz L_spdd
    s_sleep 1
    s_cmp_lt_u32 s60, 0x400000
    s_cbranch_scc1 L_spd
L_spdd:
L_pown:
    v_mov_b32 v160, 162304
    ds_read_b32 v161, v160 offset:20
    s_mov_b32 s50, 3277
    s_lshl_b32 s51, s42, 7
    v_add_u32 v144, s51, v0
    v_mul_u32_u24 v145, s50, v144
    v_lshrrev_b32 v145, 16, v145
    v_mul_u32_u24 v146, 20, v145
    v_sub_u32 v146, v144, v146
    v_and_b32 v6, 31, v145
    v_lshlrev_b32 v6, 6, v6
    v_and_b32 v147, 32, v145
    v_add3_u32 v6, v6, v147, s44
    v_mul_u32_u24 v6, 1280, v6
    v_lshl_add_u32 v6, v146, 3, v6
    v_mul_u32_u24 v4, 176, v145
    v_lshl_add_u32 v4, v146, 3, v4
    v_add_u32 v144, 64, v144
    v_mul_u32_u24 v145, s50, v144
    v_lshrrev_b32 v145, 16, v145
    v_mul_u32_u24 v146, 20, v145
    v_sub_u32 v146, v144, v146
    v_and_b32 v7, 31, v145
    v_lshlrev_b32 v7, 6, v7
    v_and_b32 v147, 32, v145
    v_add3_u32 v7, v7, v147, s44
    v_mul_u32_u24 v7, 1280, v7
    v_lshl_add_u32 v7, v146, 3, v7
    v_mul_u32_u24 v5, 176, v145
    v_lshl_add_u32 v5, v146, 3, v5
    s_mul_i32 s59, s45, 160
    s_mov_b32 s32, s82
    s_and_b32 s33, s83, 0xffff
    s_mov_b32 s34, 2621440
    s_mov_b32 s35, 0x00020000
    s_mul_i32 s52, s45, 80
    v_add_u32 v2, s52, v2
    v_mul_u32_u24 v3, 5120, v3
    s_xor_b32 s56, s44, s58
    s_add_u32 s56, s56, s57
    s_and_b32 s56, s56, 31
    s_mul_i32 s56, s56, 81920
    s_mul_i32 s52, s49, 20480
    s_add_u32 s56, s56, s52
    s_add_u32 s56, s56, 12582912
    s_cmp_ge_u32 s45, 4
    s_cselect_b32 s57, 640, -1
    s_waitcnt lgkmcnt(0)
    v_readfirstlane_b32 s47, v161
    s_cmp_eq_u32 s42, 7
    s_cbranch_scc1 L_sv2
    v_mov_b32 v144, 162328
    s_mov_b32 s60, 0
L_s1:
    ds_read_b32 v145, v144
    s_add_u32 s60, s60, 1
    s_waitcnt lgkmcnt(0)
    v_cmp_gt_u32 vcc, 1, v145
    s_cbranch_vccz L_s1d
    s_sleep 1
    s_cmp_lt_u32 s60, 0x400000
    s_cbranch_scc1 L_s1
L_s1d:
    s_branch L_k2p
L_sv2:
    s_lshr_b32 s50, s44, 2
    s_lshl_b32 s50, s50, 5
    v_min_u32 v144, 26, v0
    v_add_u32 v144, s50, v144
    v_lshlrev_b32 v144, 7, v144
    s_mov_b32 s50, 32768
    s_mov_b32 s60, 0
L_p2:
    buffer_load_dword v145, v144, s[16:19], s50 offen sc1
    s_add_u32 s60, s60, 1
    s_waitcnt vmcnt(0)
    v_cmp_ne_u32 vcc, s47, v145
    s_cbranch_vccz L_p2d
    s_sleep 3
    s_cmp_lt_u32 s60, 0x40000
    s_cbranch_scc1 L_p2
L_p2d:
    v_mov_b32 v145, 1
    ds_write_b32 v160, v145 offset:24
    s_mul_i32 s30, s27, 5120
    s_add_u32 s30, s30, s25
    s_add_u32 s31, s30, 4096
    buffer_load_dwordx4 v[88:91], v1, s[16:19], s30 offen offset:0 sc1
    buffer_load_dwordx4 v[92:95], v1, s[16:19], s30 offen offset:1024 sc1
    buffer_load_dwordx4 v[96:99], v1, s[16:19], s30 offen offset:2048 sc1
    buffer_load_dwordx4 v[100:103], v1, s[16:19], s30 offen offset:3072 sc1
    buffer_load_dwordx4 v[104:107], v1, s[16:19], s31 offen sc1
    s_add_u32 s27, s27, 1
    s_cmp_eq_u32 s27, 6
    s_cselect_b32 s27, 0, s27
    s_mul_i32 s30, s27, 5120
    s_add_u32 s30, s30, s25
    s_add_u32 s31, s30, 4096
    buffer_load_dwordx4 v[108:111], v1, s[16:19], s30 offen offset:0 sc1
    buffer_load_dwordx4 v[112:115], v1, s[16:19], s30 offen offset:1024 sc1
    buffer_load_dwordx4 v[116:119], v1, s[16:19], s30 offen offset:2048 sc1
    buffer_load_dwordx4 v[120:123], v1, s[16:19], s30 offen offset:3072 sc1
    buffer_load_dwordx4 v[124:127], v1, s[16:19], s31 offen sc1
    s_add_u32 s27, s27, 1
    s_cmp_eq_u32 s27, 6
    s_cselect_b32 s27, 0, s27
L_k2p:
    s_setprio 0
    s_lshl_b32 s52, s28, 17
    s_add_u32 s52, s52, s26
    buffer_load_dwordx4 v[144:147], v1, s[16:19], s52 offen offset:0 sc1
    buffer_load_dwordx4 v[148:151], v1, s[16:19], s52 offen offset:1024 sc1
    buffer_load_dwordx4 v[152:155], v1, s[16:19], s52 offen offset:2048 sc1
    buffer_load_dwordx4 v[156:159], v1, s[16:19], s52 offen offset:3072 sc1
    s_add_u32 s28, s28, 1
    s_cmp_eq_u32 s28, 6
    s_cselect_b32 s28, 0, s28
    s_lshl_b32 s52, s28, 17
    s_add_u32 s52, s52, s26
    buffer_load_dwordx4 v[160:163], v1, s[16:19], s52 offen offset:0 sc1
    buffer_load_dwordx4 v[164:167], v1, s[16:19], s52 offen offset:1024 sc1
    buffer_load_dwordx4 v[168:171], v1, s[16:19], s52 offen offset:2048 sc1
    buffer_load_dwordx4 v[172:175], v1, s[16:19], s52 offen offset:3072 sc1
    s_add_u32 s28, s28, 1
    s_cmp_eq_u32 s28, 6
    s_cselect_b32 s28, 0, s28
    s_sub_u32 s50, 7, s45
    s_min_u32 s50, s50, s45
    s_add_u32 s51, s50, 27
    s_mov_b32 s50, 32768
    s_waitcnt vmcnt(4)
    v_mfma_f32_16x16x32_bf16 v[176:179], v[8:11], v[144:147], v[176:179]
    s_lshl_b32 s52, s28, 17
    v_mfma_f32_16x16x32_bf16 v[180:183], v[8:11], v[148:151], v[180:183]
    s_add_u32 s52, s52, s26
    v_mfma_f32_16x16x32_bf16 v[184:187], v[8:11], v[152:155], v[184:187]
    v_mfma_f32_16x16x32_bf16 v[188:191], v[8:11], v[156:159], v[188:191]
    v_mfma_f32_16x16x32_bf16 v[192:195], v[12:15], v[144:147], v[192:195]
    buffer_load_dwordx4 v[8:11], v1, s[16:19], s52 offen offset:0 sc1
    v_mfma_f32_16x16x32_bf16 v[196:199], v[12:15], v[148:151], v[196:199]
    s_add_u32 s28, s28, 1
    v_mfma_f32_16x16x32_bf16 v[200:203], v[12:15], v[152:155], v[200:203]
    s_cmp_eq_u32 s28, 6
    v_mfma_f32_16x16x32_bf16 v[204:207], v[12:15], v[156:159], v[204:207]
    s_cselect_b32 s28, 0, s28
    v_mfma_f32_16x16x32_bf16 v[208:211], v[16:19], v[144:147], v[208:211]
    buffer_load_dwordx4 v[12:15], v1, s[16:19], s52 offen offset:1024 sc1
    v_mfma_f32_16x16x32_bf16 v[212:215], v[16:19], v[148:151], v[212:215]
    s_lshl_b32 s53, s28, 17
    v_mfma_f32_16x16x32_bf16 v[216:219], v[16:19], v[152:155], v[216:219]
    s_add_u32 s53, s53, s26
    v_mfma_f32_16x16x32_bf16 v[220:223], v[16:19], v[156:159], v[220:223]
    v_mfma_f32_16x16x32_bf16 v[224:227], v[20:23], v[144:147], v[224:227]
    buffer_load_dwordx4 v[16:19], v1, s[16:19], s52 offen offset:2048 sc1
    v_mfma_f32_16x16x32_bf16 v[228:231], v[20:23], v[148:151], v[228:231]
    s_add_u32 s28, s28, 1
    v_mfma_f32_16x16x32_bf16 v[232:235], v[20:23], v[152:155], v[232:235]
    s_cmp_eq_u32 s28, 6
    v_mfma_f32_16x16x32_bf16 v[236:239], v[20:23], v[156:159], v[236:239]
    s_cselect_b32 s28, 0, s28
    v_mfma_f32_16x16x32_bf16 v[240:243], v[24:27], v[144:147], v[240:243]
    buffer_load_dwordx4 v[20:23], v1, s[16:19], s52 offen offset:3072 sc1
    buffer_load_dwordx4 v[144:147], v1, s[16:19], s53 offen offset:0 sc1
    v_mfma_f32_16x16x32_bf16 v[244:247], v[24:27], v[148:151], v[244:247]
    buffer_load_dwordx4 v[148:151], v1, s[16:19], s53 offen offset:1024 sc1
    v_mfma_f32_16x16x32_bf16 v[248:251], v[24:27], v[152:155], v[248:251]
    buffer_load_dwordx4 v[152:155], v1, s[16:19], s53 offen offset:2048 sc1
    v_mfma_f32_16x16x32_bf16 v[252:255], v[24:27], v[156:159], v[252:255]
    buffer_load_dwordx4 v[156:159], v1, s[16:19], s53 offen offset:3072 sc1
    v_and_b32 v24, 7, v0
    v_lshlrev_b32 v24, 5, v24
    v_bfe_u32 v25, v0, 3, 1
    v_add3_u32 v24, v24, v25, s51
    v_lshlrev_b32 v24, 7, v24
    s_waitcnt vmcnt(8)
    v_mfma_f32_16x16x32_bf16 v[176:179], v[28:31], v[160:163], v[176:179]
    s_lshl_b32 s52, s28, 17
    v_mfma_f32_16x16x32_bf16 v[180:183], v[28:31], v[164:167], v[180:183]
    s_add_u32 s52, s52, s26
    v_mfma_f32_16x16x32_bf16 v[184:187], v[28:31], v[168:171], v[184:187]
    buffer_load_dword v25, v24, s[16:19], s50 offen sc1
    v_mfma_f32_16x16x32_bf16 v[188:191], v[28:31], v[172:175], v[188:191]
    v_mfma_f32_16x16x32_bf16 v[192:195], v[32:35], v[160:163], v[192:195]
    buffer_load_dwordx4 v[28:31], v1, s[16:19], s52 offen offset:0 sc1
    v_mfma_f32_16x16x32_bf16 v[196:199], v[32:35], v[164:167], v[196:199]
    s_add_u32 s28, s28, 1
    v_mfma_f32_16x16x32_bf16 v[200:203], v[32:35], v[168:171], v[200:203]
    s_cmp_eq_u32 s28, 6
    v_mfma_f32_16x16x32_bf16 v[204:207], v[32:35], v[172:175], v[204:207]
    s_cselect_b32 s28, 0, s28
    v_mfma_f32_16x16x32_bf16 v[208:211], v[36:39], v[160:163], v[208:211]
    buffer_load_dwordx4 v[32:35], v1, s[16:19], s52 offen offset:1024 sc1
    v_mfma_f32_16x16x32_bf16 v[212:215], v[36:39], v[164:167], v[212:215]
    s_lshl_b32 s53, s28, 17
    v_mfma_f32_16x16x32_bf16 v[216:219], v[36:39], v[168:171], v[216:219]
    s_add_u32 s53, s53, s26
    v_mfma_f32_16x16x32_bf16 v[220:223], v[36:39], v[172:175], v[220:223]
    v_mfma_f32_16x16x32_bf16 v[224:227], v[40:43], v[160:163], v[224:227]
    buffer_load_dwordx4 v[36:39], v1, s[16:19], s52 offen offset:2048 sc1
    v_mfma_f32_16x16x32_bf16 v[228:231], v[40:43], v[164:167], v[228:231]
    s_add_u32 s28, s28, 1
    v_mfma_f32_16x16x32_bf16 v[232:235], v[40:43], v[168:171], v[232:235]
    s_cmp_eq_u32 s28, 6
    v_mfma_f32_16x16x32_bf16 v[236:239], v[40:43], v[172:175], v[236:239]
    s_cselect_b32 s28, 0, s28
    v_mfma_f32_16x16x32_bf16 v[240:243], v[44:47], v[160:163], v[240:243]
    buffer_load_dwordx4 v[40:43], v1, s[16:19], s52 offen offset:3072 sc1
    buffer_load_dwordx4 v[160:163], v1, s[16:19], s53 offen offset:0 sc1
    v_mfma_f32_16x16x32_bf16 v[244:247], v[44:47], v[164:167], v[244:247]
    buffer_load_dwordx4 v[164:167], v1, s[16:19], s53 offen offset:1024 sc1
    v_mfma_f32_16x16x32_bf16 v[248:251], v[44:47], v[168:171], v[248:251]
    buffer_load_dwordx4 v[168:171], v1, s[16:19], s53 offen offset:2048 sc1
    v_mfma_f32_16x16x32_bf16 v[252:255], v[44:47], v[172:175], v[252:255]
    buffer_load_dwordx4 v[172:175], v1, s[16:19], s53 offen offset:3072 sc1
    s_setprio 0
    s_waitcnt vmcnt(13)
    v_mfma_f32_16x16x32_bf16 v[176:179], v[48:51], v[8:11], v[176:179]
    v_mfma_f32_16x16x32_bf16 v[180:183], v[48:51], v[12:15], v[180:183]
    v_mfma_f32_16x16x32_bf16 v[184:187], v[48:51], v[16:19], v[184:187]
    v_mfma_f32_16x16x32_bf16 v[188:191], v[48:51], v[20:23], v[188:191]
    v_mfma_f32_16x16x32_bf16 v[192:195], v[52:55], v[8:11], v[192:195]
    v_mfma_f32_16x16x32_bf16 v[196:199], v[52:55], v[12:15], v[196:199]
    v_mfma_f32_16x16x32_bf16 v[200:203], v[52:55], v[16:19], v[200:203]
    v_mfma_f32_16x16x32_bf16 v[204:207], v[52:55], v[20:23], v[204:207]
    v_mfma_f32_16x16x32_bf16 v[208:211], v[56:59], v[8:11], v[208:211]
    v_mfma_f32_16x16x32_bf16 v[212:215], v[56:59], v[12:15], v[212:215]
    v_mfma_f32_16x16x32_bf16 v[216:219], v[56:59], v[16:19], v[216:219]
    v_mfma_f32_16x16x32_bf16 v[220:223], v[56:59], v[20:23], v[220:223]
    v_mfma_f32_16x16x32_bf16 v[224:227], v[60:63], v[8:11], v[224:227]
    v_mfma_f32_16x16x32_bf16 v[228:231], v[60:63], v[12:15], v[228:231]
    v_mfma_f32_16x16x32_bf16 v[232:235], v[60:63], v[16:19], v[232:235]
    v_mfma_f32_16x16x32_bf16 v[236:239], v[60:63], v[20:23], v[236:239]
    v_mfma_f32_16x16x32_bf16 v[240:243], v[64:67], v[8:11], v[240:243]
    v_mfma_f32_16x16x32_bf16 v[244:247], v[64:67], v[12:15], v[244:247]
    v_mfma_f32_16x16x32_bf16 v[248:251], v[64:67], v[16:19], v[248:251]
    v_mfma_f32_16x16x32_bf16 v[252:255], v[64:67], v[20:23], v[252:255]
    s_waitcnt vmcnt(8)
    v_cmp_ne_u32 vcc, s47, v25
    s_cbranch_vccz L_pgd
    s_mov_b32 s60, 0
L_pg:
    buffer_load_dword v25, v24, s[16:19], s50 offen sc1
    s_add_u32 s60, s60, 1
    s_waitcnt vmcnt(0)
    v_cmp_ne_u32 vcc, s47, v25
    s_cbranch_vccz L_pgd
    s_sleep 2
    s_cmp_lt_u32 s60, 0x40000
    s_cbranch_scc1 L_pg
L_pgd:
    v_add_u32 v8, 0, v2
    v_xor_b32 v9, s58, v8
    v_add_u32 v9, s57, v9
    v_lshl_add_u32 v9, v9, 4, v3
    v_cmp_eq_u32 vcc, 0, v8
    v_mov_b32 v10, 0x40000000
    s_nop 0
    v_cndmask_b32 v9, v9, v10, vcc
    buffer_load_dwordx4 v[48:51], v9, s[16:19], s56 offen sc1
    v_add_u32 v8, 16, v2
    v_xor_b32 v9, s58, v8
    v_add_u32 v9, s57, v9
    v_lshl_add_u32 v9, v9, 4, v3
    buffer_load_dwordx4 v[52:55], v9, s[16:19], s56 offen sc1
    v_add_u32 v8, 32, v2
    v_xor_b32 v9, s58, v8
    v_add_u32 v9, s57, v9
    v_lshl_add_u32 v9, v9, 4, v3
    buffer_load_dwordx4 v[56:59], v9, s[16:19], s56 offen sc1
    v_add_u32 v8, 48, v2
    v_xor_b32 v9, s58, v8
    v_add_u32 v9, s57, v9
    v_lshl_add_u32 v9, v9, 4, v3
    buffer_load_dwordx4 v[60:63], v9, s[16:19], s56 offen sc1
    v_add_u32 v8, 64, v2
    v_xor_b32 v9, s58, v8
    v_add_u32 v9, s57, v9
    v_lshl_add_u32 v9, v9, 4, v3
    buffer_load_dwordx4 v[64:67], v9, s[16:19], s56 offen sc1
    v_mfma_f32_16x16x32_bf16 v[176:179], v[68:71], v[144:147], v[176:179]
    v_mfma_f32_16x16x32_bf16 v[180:183], v[68:71], v[148:151], v[180:183]
    v_mfma_f32_16x16x32_bf16 v[184:187], v[68:71], v[152:155], v[184:187]
    v_mfma_f32_16x16x32_bf16 v[188:191], v[68:71], v[156:159], v[188:191]
    v_mfma_f32_16x16x32_bf16 v[192:195], v[72:75], v[144:147], v[192:195]
    v_mfma_f32_16x16x32_bf16 v[196:199], v[72:75], v[148:151], v[196:199]
    v_mfma_f32_16x16x32_bf16 v[200:203], v[72:75], v[152:155], v[200:203]
    v_mfma_f32_16x16x32_bf16 v[204:207], v[72:75], v[156:159], v[204:207]
    v_mfma_f32_16x16x32_bf16 v[208:211], v[76:79], v[144:147], v[208:211]
    v_mfma_f32_16x16x32_bf16 v[212:215], v[76:79], v[148:151], v[212:215]
    v_mfma_f32_16x16x32_bf16 v[216:219], v[76:79], v[152:155], v[216:219]
    v_mfma_f32_16x16x32_bf16 v[220:223], v[76:79], v[156:159], v[220:223]
    v_mfma_f32_16x16x32_bf16 v[224:227], v[80:83], v[144:147], v[224:227]
    v_mfma_f32_16x16x32_bf16 v[228:231], v[80:83], v[148:151], v[228:231]
    v_mfma_f32_16x16x32_bf16 v[232:235], v[80:83], v[152:155], v[232:235]
    v_mfma_f32_16x16x32_bf16 v[236:239], v[80:83], v[156:159], v[236:239]
    v_mfma_f32_16x16x32_bf16 v[240:243], v[84:87], v[144:147], v[240:243]
    v_mfma_f32_16x16x32_bf16 v[244:247], v[84:87], v[148:151], v[244:247]
    v_mfma_f32_16x16x32_bf16 v[248:251], v[84:87], v[152:155], v[248:251]
    v_mfma_f32_16x16x32_bf16 v[252:255], v[84:87], v[156:159], v[252:255]
    s_waitcnt vmcnt(9)
    v_mfma_f32_16x16x32_bf16 v[176:179], v[88:91], v[28:31], v[176:179]
    v_mfma_f32_16x16x32_bf16 v[180:183], v[88:91], v[32:35], v[180:183]
    v_mfma_f32_16x16x32_bf16 v[184:187], v[88:91], v[36:39], v[184:187]
    v_mfma_f32_16x16x32_bf16 v[188:191], v[88:91], v[40:43], v[188:191]
    v_mfma_f32_16x16x32_bf16 v[192:195], v[92:95], v[28:31], v[192:195]
    v_mfma_f32_16x16x32_bf16 v[196:199], v[92:95], v[32:35], v[196:199]
    v_mfma_f32_16x16x32_bf16 v[200:203], v[92:95], v[36:39], v[200:203]
    v_mfma_f32_16x16x32_bf16 v[204:207], v[92:95], v[40:43], v[204:207]
    v_mfma_f32_16x16x32_bf16 v[208:211], v[96:99], v[28:31], v[208:211]
    v_mfma_f32_16x16x32_bf16 v[212:215], v[96:99], v[32:35], v[212:215]
    v_mfma_f32_16x16x32_bf16 v[216:219], v[96:99], v[36:39], v[216:219]
    v_mfma_f32_16x16x32_bf16 v[220:223], v[96:99], v[40:43], v[220:223]
    v_mfma_f32_16x16x32_bf16 v[224:227], v[100:103], v[28:31], v[224:227]
    v_mfma_f32_16x16x32_bf16 v[228:231], v[100:103], v[32:35], v[228:231]
    v_mfma_f32_16x16x32_bf16 v[232:235], v[100:103], v[36:39], v[232:235]
    v_mfma_f32_16x16x32_bf16 v[236:239], v[100:103], v[40:43], v[236:239]
    v_mfma_f32_16x16x32_bf16 v[240:243], v[104:107], v[28:31], v[240:243]
    v_mfma_f32_16x16x32_bf16 v[244:247], v[104:107], v[32:35], v[244:247]
    v_mfma_f32_16x16x32_bf16 v[248:251], v[104:107], v[36:39], v[248:251]
    v_mfma_f32_16x16x32_bf16 v[252:255], v[104:107], v[40:43], v[252:255]
    v_and_b32 v16, 15, v0
    v_lshrrev_b32 v17, 4, v0
    v_mul_u32_u24 v16, 176, v16
    v_lshl_add_u32 v16, v17, 3, v16
    s_mul_i32 s50, s49, 40960
    s_cmp_eq_u32 s49, 3
    s_cselect_b32 s50, 117760, s50
    s_add_u32 s50, s50, 11264
    v_add_u32 v2, s50, v16
    s_lshl_b32 s50, s49, 2
    s_add_u32 s50, s50, 162336
    v_mov_b32 v16, s50
    s_mov_b32 s60, 0
L_pf:
    ds_read_b32 v17, v16
    s_add_u32 s60, s60, 1
    s_waitcnt lgkmcnt(0)
    v_cmp_gt_u32 vcc, 1, v17
    s_cbranch_vccz L_pfd
    s_sleep 1
    s_cmp_lt_u32 s60, 0x400000
    s_cbranch_scc1 L_pf
L_pfd:
    s_waitcnt vmcnt(0)
    v_mfma_f32_16x16x32_bf16 v[176:179], v[108:111], v[160:163], v[176:179]
    v_mfma_f32_16x16x32_bf16 v[180:183], v[108:111], v[164:167], v[180:183]
    v_mfma_f32_16x16x32_bf16 v[184:187], v[108:111], v[168:171], v[184:187]
    v_mfma_f32_16x16x32_bf16 v[188:191], v[108:111], v[172:175], v[188:191]
    v_mfma_f32_16x16x32_bf16 v[176:179], v[48:51], v[128:131], v[176:179]
    v_mfma_f32_16x16x32_bf16 v[180:183], v[48:51], v[132:135], v[180:183]
    v_mfma_f32_16x16x32_bf16 v[184:187], v[48:51], v[136:139], v[184:187]
    v_mfma_f32_16x16x32_bf16 v[188:191], v[48:51], v[140:143], v[188:191]
    v_mfma_f32_16x16x32_bf16 v[192:195], v[112:115], v[160:163], v[192:195]
    v_mfma_f32_16x16x32_bf16 v[196:199], v[112:115], v[164:167], v[196:199]
    v_mfma_f32_16x16x32_bf16 v[200:203], v[112:115], v[168:171], v[200:203]
    v_mfma_f32_16x16x32_bf16 v[204:207], v[112:115], v[172:175], v[204:207]
    v_mfma_f32_16x16x32_bf16 v[192:195], v[52:55], v[128:131], v[192:195]
    v_cvt_pk_bf16_f32 v176, v176, v177
    v_cvt_pk_bf16_f32 v177, v178, v179
    ds_write_b64 v2, v[176:177] offset:0
    v_mfma_f32_16x16x32_bf16 v[196:199], v[52:55], v[132:135], v[196:199]
    v_cvt_pk_bf16_f32 v180, v180, v181
    v_cvt_pk_bf16_f32 v181, v182, v183
    ds_write_b64 v2, v[180:181] offset:2816
    v_mfma_f32_16x16x32_bf16 v[200:203], v[52:55], v[136:139], v[200:203]
    v_cvt_pk_bf16_f32 v184, v184, v185
    v_cvt_pk_bf16_f32 v185, v186, v187
    ds_write_b64 v2, v[184:185] offset:5632
    v_mfma_f32_16x16x32_bf16 v[204:207], v[52:55], v[140:143], v[204:207]
    v_cvt_pk_bf16_f32 v188, v188, v189
    v_cvt_pk_bf16_f32 v189, v190, v191
    ds_write_b64 v2, v[188:189] offset:8448
    v_mfma_f32_16x16x32_bf16 v[208:211], v[116:119], v[160:163], v[208:211]
    v_mfma_f32_16x16x32_bf16 v[212:215], v[116:119], v[164:167], v[212:215]
    v_mfma_f32_16x16x32_bf16 v[216:219], v[116:119], v[168:171], v[216:219]
    v_mfma_f32_16x16x32_bf16 v[220:223], v[116:119], v[172:175], v[220:223]
    v_mfma_f32_16x16x32_bf16 v[208:211], v[56:59], v[128:131], v[208:211]
    v_cvt_pk_bf16_f32 v192, v192, v193
    v_cvt_pk_bf16_f32 v193, v194, v195
    ds_write_b64 v2, v[192:193] offset:32
    v_mfma_f32_16x16x32_bf16 v[212:215], v[56:59], v[132:135], v[212:215]
    v_cvt_pk_bf16_f32 v196, v196, v197
    v_cvt_pk_bf16_f32 v197, v198, v199
    ds_write_b64 v2, v[196:197] offset:2848
    v_mfma_f32_16x16x32_bf16 v[216:219], v[56:59], v[136:139], v[216:219]
    v_cvt_pk_bf16_f32 v200, v200, v201
    v_cvt_pk_bf16_f32 v201, v202, v203
    ds_write_b64 v2, v[200:201] offset:5664
    v_mfma_f32_16x16x32_bf16 v[220:223], v[56:59], v[140:143], v[220:223]
    v_cvt_pk_bf16_f32 v204, v204, v205
    v_cvt_pk_bf16_f32 v205, v206, v207
    ds_write_b64 v2, v[204:205] offset:8480
    v_mfma_f32_16x16x32_bf16 v[224:227], v[120:123], v[160:163], v[224:227]
    v_mfma_f32_16x16x32_bf16 v[228:231], v[120:123], v[164:167], v[228:231]
    v_mfma_f32_16x16x32_bf16 v[232:235], v[120:123], v[168:171], v[232:235]
    v_mfma_f32_16x16x32_bf16 v[236:239], v[120:123], v[172:175], v[236:239]
    v_mfma_f32_16x16x32_bf16 v[224:227], v[60:63], v[128:131], v[224:227]
    v_cvt_pk_bf16_f32 v208, v208, v209
    v_cvt_pk_bf16_f32 v209, v210, v211
    ds_write_b64 v2, v[208:209] offset:64
    v_mfma_f32_16x16x32_bf16 v[228:231], v[60:63], v[132:135], v[228:231]
    v_cvt_pk_bf16_f32 v212, v212, v213
    v_cvt_pk_bf16_f32 v213, v214, v215
    ds_write_b64 v2, v[212:213] offset:2880
    v_mfma_f32_16x16x32_bf16 v[232:235], v[60:63], v[136:139], v[232:235]
    v_cvt_pk_bf16_f32 v216, v216, v217
    v_cvt_pk_bf16_f32 v217, v218, v219
    ds_write_b64 v2, v[216:217] offset:5696
    v_mfma_f32_16x16x32_bf16 v[236:239], v[60:63], v[140:143], v[236:239]
    v_cvt_pk_bf16_f32 v220, v220, v221
    v_cvt_pk_bf16_f32 v221, v222, v223
    ds_write_b64 v2, v[220:221] offset:8512
    v_mfma_f32_16x16x32_bf16 v[240:243], v[124:127], v[160:163], v[240:243]
    v_mfma_f32_16x16x32_bf16 v[244:247], v[124:127], v[164:167], v[244:247]
    v_mfma_f32_16x16x32_bf16 v[248:251], v[124:127], v[168:171], v[248:251]
    v_mfma_f32_16x16x32_bf16 v[252:255], v[124:127], v[172:175], v[252:255]
    v_mfma_f32_16x16x32_bf16 v[240:243], v[64:67], v[128:131], v[240:243]
    v_cvt_pk_bf16_f32 v224, v224, v225
    v_cvt_pk_bf16_f32 v225, v226, v227
    ds_write_b64 v2, v[224:225] offset:96
    v_mfma_f32_16x16x32_bf16 v[244:247], v[64:67], v[132:135], v[244:247]
    v_cvt_pk_bf16_f32 v228, v228, v229
    v_cvt_pk_bf16_f32 v229, v230, v231
    ds_write_b64 v2, v[228:229] offset:2912
    v_mfma_f32_16x16x32_bf16 v[248:251], v[64:67], v[136:139], v[248:251]
    v_cvt_pk_bf16_f32 v232, v232, v233
    v_cvt_pk_bf16_f32 v233, v234, v235
    ds_write_b64 v2, v[232:233] offset:5728
    v_mfma_f32_16x16x32_bf16 v[252:255], v[64:67], v[140:143], v[252:255]
    v_cvt_pk_bf16_f32 v236, v236, v237
    v_cvt_pk_bf16_f32 v237, v238, v239
    ds_write_b64 v2, v[236:237] offset:8544
    s_nop 7
    v_cvt_pk_bf16_f32 v240, v240, v241
    v_cvt_pk_bf16_f32 v241, v242, v243
    ds_write_b64 v2, v[240:241] offset:128
    v_cvt_pk_bf16_f32 v244, v244, v245
    v_cvt_pk_bf16_f32 v245, v246, v247
    ds_write_b64 v2, v[244:245] offset:2944
    v_cvt_pk_bf16_f32 v248, v248, v249
    v_cvt_pk_bf16_f32 v249, v250, v251
    ds_write_b64 v2, v[248:249] offset:5760
    v_cvt_pk_bf16_f32 v252, v252, v253
    v_cvt_pk_bf16_f32 v253, v254, v255
    ds_write_b64 v2, v[252:253] offset:8576
    s_branch L_final
L_cons:
    s_and_b32 s47, s42, 1
    s_lshr_b32 s49, s42, 1
    v_and_b32 v2, 15, v0
    v_lshrrev_b32 v3, 4, v0
    v_bfe_u32 v6, v0, 1, 3
    s_lshl_b32 s50, s49, 14
    v_lshlrev_b32 v1, 7, v2
    v_add_u32 v1, s50, v1
    v_xor_b32 v7, v3, v6
    v_lshl_add_u32 v8, v7, 4, v1
    v_xor_b32 v9, 64, v8
    s_add_u32 s52, s42, 1
    s_and_b32 s52, s52, 2
    s_cmp_eq_u32 s52, 0
    s_cbranch_scc1 L_ch3
    s_sub_u32 s52, s42, 1
    s_mov_b32 s53, s36
    s_mov_b32 s54, s40
    v_mul_u32_u24 v6, 1280, v3
    v_lshl_add_u32 v6, v2, 4, v6
    s_lshl_b32 s50, s53, 6
    s_lshl_b32 s51, s52, 5
    s_add_u32 s50, s50, s51
    s_lshl_b32 s51, s54, 2
    s_add_u32 s50, s50, s51
    s_mul_i32 s50, s50, 1280
    s_waitcnt lgkmcnt(0)
    s_mov_b32 s4, s64
    s_and_b32 s5, s65, 0xffff
    s_mov_b32 s6, 2621440
    s_mov_b32 s7, 0x00020000
    buffer_load_dwordx4 v[16:19], v6, s[4:7], s50 offen offset:0
    buffer_load_dwordx4 v[20:23], v6, s[4:7], s50 offen offset:256
    buffer_load_dwordx4 v[24:27], v6, s[4:7], s50 offen offset:512
    buffer_load_dwordx4 v[28:31], v6, s[4:7], s50 offen offset:768
    buffer_load_dwordx4 v[32:35], v6, s[4:7], s50 offen offset:1024
    s_mov_b32 s16, s86
    s_and_b32 s17, s87, 0xffff
    s_mov_b32 s18, 16777216
    s_mov_b32 s19, 0x00020000
    v_mov_b32 v128, 0
    v_mov_b32 v129, 0
    v_mov_b32 v130, 0
    v_mov_b32 v131, 0
    v_mov_b32 v132, 0
    v_mov_b32 v133, 0
    v_mov_b32 v134, 0
    v_mov_b32 v135, 0
    v_mov_b32 v136, 0
    v_mov_b32 v137, 0
    v_mov_b32 v138, 0
    v_mov_b32 v139, 0
    v_mov_b32 v140, 0
    v_mov_b32 v141, 0
    v_mov_b32 v142, 0
    v_mov_b32 v143, 0
    v_mov_b32 v144, 0
    v_mov_b32 v145, 0
    v_mov_b32 v146, 0
    v_mov_b32 v147, 0
    v_mov_b32 v148, 0
    v_mov_b32 v149, 0
    v_mov_b32 v150, 0
    v_mov_b32 v151, 0
    v_mov_b32 v152, 0
    v_mov_b32 v153, 0
    v_mov_b32 v154, 0
    v_mov_b32 v155, 0
    v_mov_b32 v156, 0
    v_mov_b32 v157, 0
    v_mov_b32 v158, 0
    v_mov_b32 v159, 0
    v_mov_b32 v160, 0
    v_mov_b32 v161, 0
    v_mov_b32 v162, 0
    v_mov_b32 v163, 0
    v_mov_b32 v164, 0
    v_mov_b32 v165, 0
    v_mov_b32 v166, 0
    v_mov_b32 v167, 0
    v_mov_b32 v168, 0
    v_mov_b32 v169, 0
    v_mov_b32 v170, 0
    v_mov_b32 v171, 0
    v_mov_b32 v172, 0
    v_mov_b32 v173, 0
    v_mov_b32 v174, 0
    v_mov_b32 v175, 0
    v_mov_b32 v176, 0
    v_mov_b32 v177, 0
    v_mov_b32 v178, 0
    v_mov_b32 v179, 0
    v_mov_b32 v180, 0
    v_mov_b32 v181, 0
    v_mov_b32 v182, 0
    v_mov_b32 v183, 0
    v_mov_b32 v184, 0
    v_mov_b32 v185, 0
    v_mov_b32 v186, 0
    v_mov_b32 v187, 0
    v_mov_b32 v188, 0
    v_mov_b32 v189, 0
    v_mov_b32 v190, 0
    v_mov_b32 v191, 0
    v_mov_b32 v192, 0
    v_mov_b32 v193, 0
    v_mov_b32 v194, 0
    v_mov_b32 v195, 0
    v_mov_b32 v196, 0
    v_mov_b32 v197, 0
    v_mov_b32 v198, 0
    v_mov_b32 v199, 0
    v_mov_b32 v200, 0
    v_mov_b32 v201, 0
    v_mov_b32 v202, 0
    v_mov_b32 v203, 0
    v_mov_b32 v204, 0
    v_mov_b32 v205, 0
    v_mov_b32 v206, 0
    v_mov_b32 v207, 0
    v_mov_b32 v208, 0
    v_mov_b32 v209, 0
    v_mov_b32 v210, 0
    v_mov_b32 v211, 0
    v_mov_b32 v212, 0
    v_mov_b32 v213, 0
    v_mov_b32 v214, 0
    v_mov_b32 v215, 0
    v_mov_b32 v216, 0
    v_mov_b32 v217, 0
    v_mov_b32 v218, 0
    v_mov_b32 v219, 0
    v_mov_b32 v220, 0
    v_mov_b32 v221, 0
    v_mov_b32 v222, 0
    v_mov_b32 v223, 0
    v_mov_b32 v224, 0
    v_mov_b32 v225, 0
    v_mov_b32 v226, 0
    v_mov_b32 v227, 0
    v_mov_b32 v228, 0
    v_mov_b32 v229, 0
    v_mov_b32 v230, 0
    v_mov_b32 v231, 0
    v_mov_b32 v232, 0
    v_mov_b32 v233, 0
    v_mov_b32 v234, 0
    v_mov_b32 v235, 0
    v_mov_b32 v236, 0
    v_mov_b32 v237, 0
    v_mov_b32 v238, 0
    v_mov_b32 v239, 0
    v_mov_b32 v240, 0
    v_mov_b32 v241, 0
    v_mov_b32 v242, 0
    v_mov_b32 v243, 0
    v_mov_b32 v244, 0
    v_mov_b32 v245, 0
    v_mov_b32 v246, 0
    v_mov_b32 v247, 0
    v_mov_b32 v248, 0
    v_mov_b32 v249, 0
    v_mov_b32 v250, 0
    v_mov_b32 v251, 0
    v_mov_b32 v252, 0
    v_mov_b32 v253, 0
    v_mov_b32 v254, 0
    v_mov_b32 v255, 0
    v_mov_b32 v40, 0
    v_mov_b32 v41, 0
    v_mov_b32 v42, 0
    v_mov_b32 v43, 0
    v_mov_b32 v44, 0
    v_mov_b32 v45, 0
    v_mov_b32 v46, 0
    v_mov_b32 v47, 0
    s_lshl_b32 s50, s54, 11
    s_lshl_b32 s51, s52, 10
    s_add_u32 s50, s50, s51
    s_lshl_b32 s51, s53, 3
    s_add_u32 s50, s50, s51
    v_lshlrev_b32 v4, 8, v3
    s_waitcnt vmcnt(0)
    v_lshlrev_b32 v36, 16, v16
    s_nop 1
    v_mov_b32_dpp v36, v36 row_newbcast:0 row_mask:0xf bank_mask:0xf
    v_lshlrev_b32 v48, 16, v16
    v_and_b32 v49, 0xffff0000, v16
    v_lshlrev_b32 v50, 16, v17
    v_and_b32 v51, 0xffff0000, v17
    v_lshlrev_b32 v52, 16, v18
    v_and_b32 v53, 0xffff0000, v18
    v_lshlrev_b32 v54, 16, v19
    v_and_b32 v55, 0xffff0000, v19
    v_pk_add_f32 v[48:49], v[48:49], v[36:37] op_sel_hi:[1,0] neg_lo:[0,1] neg_hi:[0,1]
    v_pk_add_f32 v[50:51], v[50:51], v[36:37] op_sel_hi:[1,0] neg_lo:[0,1] neg_hi:[0,1]
    v_pk_add_f32 v[52:53], v[52:53], v[36:37] op_sel_hi:[1,0] neg_lo:[0,1] neg_hi:[0,1]
    v_pk_add_f32 v[54:55], v[54:55], v[36:37] op_sel_hi:[1,0] neg_lo:[0,1] neg_hi:[0,1]
    v_pk_add_f32 v[40:41], v[40:41], v[48:49]
    v_pk_add_f32 v[42:43], v[42:43], v[50:51]
    v_pk_add_f32 v[40:41], v[40:41], v[52:53]
    v_pk_add_f32 v[42:43], v[42:43], v[54:55]
    v_pk_fma_f32 v[44:45], v[48:49], v[48:49], v[44:45]
    v_pk_fma_f32 v[46:47], v[50:51], v[50:51], v[46:47]
    v_pk_fma_f32 v[44:45], v[52:53], v[52:53], v[44:45]
    v_pk_fma_f32 v[46:47], v[54:55], v[54:55], v[46:47]
    v_lshlrev_b32 v48, 16, v20
    v_and_b32 v49, 0xffff0000, v20
    v_lshlrev_b32 v50, 16, v21
    v_and_b32 v51, 0xffff0000, v21
    v_lshlrev_b32 v52, 16, v22
    v_and_b32 v53, 0xffff0000, v22
    v_lshlrev_b32 v54, 16, v23
    v_and_b32 v55, 0xffff0000, v23
    v_pk_add_f32 v[48:49], v[48:49], v[36:37] op_sel_hi:[1,0] neg_lo:[0,1] neg_hi:[0,1]
    v_pk_add_f32 v[50:51], v[50:51], v[36:37] op_sel_hi:[1,0] neg_lo:[0,1] neg_hi:[0,1]
    v_pk_add_f32 v[52:53], v[52:53], v[36:37] op_sel_hi:[1,0] neg_lo:[0,1] neg_hi:[0,1]
    v_pk_add_f32 v[54:55], v[54:55], v[36:37] op_sel_hi:[1,0] neg_lo:[0,1] neg_hi:[0,1]
    v_pk_add_f32 v[40:41], v[40:41], v[48:49]
    v_pk_add_f32 v[42:43], v[42:43], v[50:51]
    v_pk_add_f32 v[40:41], v[40:41], v[52:53]
    v_pk_add_f32 v[42:43], v[42:43], v[54:55]
    v_pk_fma_f32 v[44:45], v[48:49], v[48:49], v[44:45]
    v_pk_fma_f32 v[46:47], v[50:51], v[50:51], v[46:47]
    v_pk_fma_f32 v[44:45], v[52:53], v[52:53], v[44:45]
    v_pk_fma_f32 v[46:47], v[54:55], v[54:55], v[46:47]
    v_lshlrev_b32 v48, 16, v24
    v_and_b32 v49, 0xffff0000, v24
    v_lshlrev_b32 v50, 16, v25
    v_and_b32 v51, 0xffff0000, v25
    v_lshlrev_b32 v52, 16, v26
    v_and_b32 v53, 0xffff0000, v26
    v_lshlrev_b32 v54, 16, v27
    v_and_b32 v55, 0xffff0000, v27
    v_pk_add_f32 v[48:49], v[48:49], v[36:37] op_sel_hi:[1,0] neg_lo:[0,1] neg_hi:[0,1]
    v_pk_add_f32 v[50:51], v[50:51], v[36:37] op_sel_hi:[1,0] neg_lo:[0,1] neg_hi:[0,1]
    v_pk_add_f32 v[52:53], v[52:53], v[36:37] op_sel_hi:[1,0] neg_lo:[0,1] neg_hi:[0,1]
    v_pk_add_f32 v[54:55], v[54:55], v[36:37] op_sel_hi:[1,0] neg_lo:[0,1] neg_hi:[0,1]
    v_pk_add_f32 v[40:41], v[40:41], v[48:49]
    v_pk_add_f32 v[42:43], v[42:43], v[50:51]
    v_pk_add_f32 v[40:41], v[40:41], v[52:53]
    v_pk_add_f32 v[42:43], v[42:43], v[54:55]
    v_pk_fma_f32 v[44:45], v[48:49], v[48:49], v[44:45]
    v_pk_fma_f32 v[46:47], v[50:51], v[50:51], v[46:47]
    v_pk_fma_f32 v[44:45], v[52:53], v[52:53], v[44:45]
    v_pk_fma_f32 v[46:47], v[54:55], v[54:55], v[46:47]
    v_lshlrev_b32 v48, 16, v28
    v_and_b32 v49, 0xffff0000, v28
    v_lshlrev_b32 v50, 16, v29
    v_and_b32 v51, 0xffff0000, v29
    v_lshlrev_b32 v52, 16, v30
    v_and_b32 v53, 0xffff0000, v30
    v_lshlrev_b32 v54, 16, v31
    v_and_b32 v55, 0xffff0000, v31
    v_pk_add_f32 v[48:49], v[48:49], v[36:37] op_sel_hi:[1,0] neg_lo:[0,1] neg_hi:[0,1]
    v_pk_add_f32 v[50:51], v[50:51], v[36:37] op_sel_hi:[1,0] neg_lo:[0,1] neg_hi:[0,1]
    v_pk_add_f32 v[52:53], v[52:53], v[36:37] op_sel_hi:[1,0] neg_lo:[0,1] neg_hi:[0,1]
    v_pk_add_f32 v[54:55], v[54:55], v[36:37] op_sel_hi:[1,0] neg_lo:[0,1] neg_hi:[0,1]
    v_pk_add_f32 v[40:41], v[40:41], v[48:49]
    v_pk_add_f32 v[42:43], v[42:43], v[50:51]
    v_pk_add_f32 v[40:41], v[40:41], v[52:53]
    v_pk_add_f32 v[42:43], v[42:43], v[54:55]
    v_pk_fma_f32 v[44:45], v[48:49], v[48:49], v[44:45]
    v_pk_fma_f32 v[46:47], v[50:51], v[50:51], v[46:47]
    v_pk_fma_f32 v[44:45], v[52:53], v[52:53], v[44:45]
    v_pk_fma_f32 v[46:47], v[54:55], v[54:55], v[46:47]
    v_lshlrev_b32 v48, 16, v32
    v_and_b32 v49, 0xffff0000, v32
    v_lshlrev_b32 v50, 16, v33
    v_and_b32 v51, 0xffff0000, v33
    v_lshlrev_b32 v52, 16, v34
    v_and_b32 v53, 0xffff0000, v34
    v_lshlrev_b32 v54, 16, v35
    v_and_b32 v55, 0xffff0000, v35
    v_pk_add_f32 v[48:49], v[48:49], v[36:37] op_sel_hi:[1,0] neg_lo:[0,1] neg_hi:[0,1]
    v_pk_add_f32 v[50:51], v[50:51], v[36:37] op_sel_hi:[1,0] neg_lo:[0,1] neg_hi:[0,1]
    v_pk_add_f32 v[52:53], v[52:53], v[36:37] op_sel_hi:[1,0] neg_lo:[0,1] neg_hi:[0,1]
    v_pk_add_f32 v[54:55], v[54:55], v[36:37] op_sel_hi:[1,0] neg_lo:[0,1] neg_hi:[0,1]
    v_pk_add_f32 v[40:41], v[40:41], v[48:49]
    v_pk_add_f32 v[42:43], v[42:43], v[50:51]
    v_pk_add_f32 v[40:41], v[40:41], v[52:53]
    v_pk_add_f32 v[42:43], v[42:43], v[54:55]
    v_pk_fma_f32 v[44:45], v[48:49], v[48:49], v[44:45]
    v_pk_fma_f32 v[46:47], v[50:51], v[50:51], v[46:47]
    v_pk_fma_f32 v[44:45], v[52:53], v[52:53], v[44:45]
    v_pk_fma_f32 v[46:47], v[54:55], v[54:55], v[46:47]
    v_pk_add_f32 v[40:41], v[40:41], v[42:43]
    v_pk_add_f32 v[44:45], v[44:45], v[46:47]
    v_add_f32 v40, v40, v41
    v_add_f32 v44, v44, v45
    s_nop 1
    v_add_f32_dpp v40, v40, v40 quad_perm:[1,0,3,2] row_mask:0xf bank_mask:0xf
    v_add_f32_dpp v44, v44, v44 quad_perm:[1,0,3,2] row_mask:0xf bank_mask:0xf
    s_nop 1
    v_add_f32_dpp v40, v40, v40 quad_perm:[2,3,0,1] row_mask:0xf bank_mask:0xf
    v_add_f32_dpp v44, v44, v44 quad_perm:[2,3,0,1] row_mask:0xf bank_mask:0xf
    s_nop 1
    v_add_f32_dpp v40, v40, v40 row_half_mirror row_mask:0xf bank_mask:0xf
    v_add_f32_dpp v44, v44, v44 row_half_mirror row_mask:0xf bank_mask:0xf
    s_nop 1
    v_add_f32_dpp v40, v40, v40 row_mirror row_mask:0xf bank_mask:0xf
    v_add_f32_dpp v44, v44, v44 row_mirror row_mask:0xf bank_mask:0xf
    v_mul_f32 v40, 0x3acccccd, v40
    v_mov_b32 v39, 0x3727c5ac
    v_fmac_f32 v39, 0x3acccccd, v44
    v_add_f32 v38, v40, v36
    v_fma_f32 v39, -v40, v40, v39
    v_max_f32 v39, 0x3727c5ac, v39
    s_mov_b32 exec_lo, 0x00010001
    s_mov_b32 exec_hi, 0x00010001
    buffer_store_dwordx2 v[38:39], v4, s[16:19], s50 offen sc1
    s_mov_b64 exec, -1
    s_branch L_chd
L_ch3:
    s_waitcnt lgkmcnt(0)
    s_mov_b32 s16, s86
    s_and_b32 s17, s87, 0xffff
    s_mov_b32 s18, 16777216
    s_mov_b32 s19, 0x00020000
    v_mov_b32 v128, 0
    v_mov_b32 v129, 0
    v_mov_b32 v130, 0
    v_mov_b32 v131, 0
    v_mov_b32 v132, 0
    v_mov_b32 v133, 0
    v_mov_b32 v134, 0
    v_mov_b32 v135, 0
    v_mov_b32 v136, 0
    v_mov_b32 v137, 0
    v_mov_b32 v138, 0
    v_mov_b32 v139, 0
    v_mov_b32 v140, 0
    v_mov_b32 v141, 0
    v_mov_b32 v142, 0
    v_mov_b32 v143, 0
    v_mov_b32 v144, 0
    v_mov_b32 v145, 0
    v_mov_b32 v146, 0
    v_mov_b32 v147, 0
    v_mov_b32 v148, 0
    v_mov_b32 v149, 0
    v_mov_b32 v150, 0
    v_mov_b32 v151, 0
    v_mov_b32 v152, 0
    v_mov_b32 v153, 0
    v_mov_b32 v154, 0
    v_mov_b32 v155, 0
    v_mov_b32 v156, 0
    v_mov_b32 v157, 0
    v_mov_b32 v158, 0
    v_mov_b32 v159, 0
    v_mov_b32 v160, 0
    v_mov_b32 v161, 0
    v_mov_b32 v162, 0
    v_mov_b32 v163, 0
    v_mov_b32 v164, 0
    v_mov_b32 v165, 0
    v_mov_b32 v166, 0
    v_mov_b32 v167, 0
    v_mov_b32 v168, 0
    v_mov_b32 v169, 0
    v_mov_b32 v170, 0
    v_mov_b32 v171, 0
    v_mov_b32 v172, 0
    v_mov_b32 v173, 0
    v_mov_b32 v174, 0
    v_mov_b32 v175, 0
    v_mov_b32 v176, 0
    v_mov_b32 v177, 0
    v_mov_b32 v178, 0
    v_mov_b32 v179, 0
    v_mov_b32 v180, 0
    v_mov_b32 v181, 0
    v_mov_b32 v182, 0
    v_mov_b32 v183, 0
    v_mov_b32 v184, 0
    v_mov_b32 v185, 0
    v_mov_b32 v186, 0
    v_mov_b32 v187, 0
    v_mov_b32 v188, 0
    v_mov_b32 v189, 0
    v_mov_b32 v190, 0
    v_mov_b32 v191, 0
    v_mov_b32 v192, 0
    v_mov_b32 v193, 0
    v_mov_b32 v194, 0
    v_mov_b32 v195, 0
    v_mov_b32 v196, 0
    v_mov_b32 v197, 0
    v_mov_b32 v198, 0
    v_mov_b32 v199, 0
    v_mov_b32 v200, 0
    v_mov_b32 v201, 0
    v_mov_b32 v202, 0
    v_mov_b32 v203, 0
    v_mov_b32 v204, 0
    v_mov_b32 v205, 0
    v_mov_b32 v206, 0
    v_mov_b32 v207, 0
    v_mov_b32 v208, 0
    v_mov_b32 v209, 0
    v_mov_b32 v210, 0
    v_mov_b32 v211, 0
    v_mov_b32 v212, 0
    v_mov_b32 v213, 0
    v_mov_b32 v214, 0
    v_mov_b32 v215, 0
    v_mov_b32 v216, 0
    v_mov_b32 v217, 0
    v_mov_b32 v218, 0
    v_mov_b32 v219, 0
    v_mov_b32 v220, 0
    v_mov_b32 v221, 0
    v_mov_b32 v222, 0
    v_mov_b32 v223, 0
    v_mov_b32 v224, 0
    v_mov_b32 v225, 0
    v_mov_b32 v226, 0
    v_mov_b32 v227, 0
    v_mov_b32 v228, 0
    v_mov_b32 v229, 0
    v_mov_b32 v230, 0
    v_mov_b32 v231, 0
    v_mov_b32 v232, 0
    v_mov_b32 v233, 0
    v_mov_b32 v234, 0
    v_mov_b32 v235, 0
    v_mov_b32 v236, 0
    v_mov_b32 v237, 0
    v_mov_b32 v238, 0
    v_mov_b32 v239, 0
    v_mov_b32 v240, 0
    v_mov_b32 v241, 0
    v_mov_b32 v242, 0
    v_mov_b32 v243, 0
    v_mov_b32 v244, 0
    v_mov_b32 v245, 0
    v_mov_b32 v246, 0
    v_mov_b32 v247, 0
    v_mov_b32 v248, 0
    v_mov_b32 v249, 0
    v_mov_b32 v250, 0
    v_mov_b32 v251, 0
    v_mov_b32 v252, 0
    v_mov_b32 v253, 0
    v_mov_b32 v254, 0
    v_mov_b32 v255, 0
L_chd:
    s_mov_b32 s60, 10
    s_mov_b32 s61, 0
    v_mov_b32 v120, 162304
    v_mov_b32 v121, 1
    s_cmp_eq_u32 s43, 1
    s_cbranch_scc1 L_cdft
    v_bfe_u32 v6, v0, 2, 2
    v_lshl_add_u32 v7, v3, 3, v6
    v_lshlrev_b32 v12, 7, v7
    v_and_b32 v7, 3, v0
    v_lshl_add_u32 v12, v7, 3, v12
    v_lshrrev_b32 v6, 1, v6
    v_and_b32 v7, 1, v3
    v_lshl_add_u32 v6, v7, 1, v6
    s_lshl_b32 s50, s47, 1
    v_xor_b32 v6, s50, v6
    v_lshl_add_u32 v12, v6, 5, v12
    v_add_u32 v12, 32768, v12
    v_xor_b32 v13, 32, v12
    s_lshl_b32 s50, s47, 7
    s_add_u32 s50, s50, 161792
    v_lshl_add_u32 v4, v3, 4, s50
    s_lshl_b32 s51, s49, 11
    s_add_u32 s51, s51, 157696
    v_lshl_add_u32 v5, v2, 4, s51
    v_lshlrev_b32 v6, 4, v0
    s_lshl_b32 s50, s41, 1
    s_add_u32 s50, s50, s47
    s_lshl_b32 s50, s50, 17
    s_lshl_b32 s51, s40, 14
    s_add_u32 s50, s50, s51
    s_lshl_b32 s51, s49, 11
    s_add_u32 s50, s50, s51
    s_add_u32 s50, s50, 4194304
    s_barrier
    ds_read_b128 v[16:19], v8 offset:0
    ds_read_b64_tr_b16 v[48:49], v12 offset:0
    ds_read_b64_tr_b16 v[50:51], v12 offset:512
    ds_read_b128 v[20:23], v8 offset:2048
    ds_read_b64_tr_b16 v[52:53], v13 offset:0
    ds_read_b64_tr_b16 v[54:55], v13 offset:512
    ds_read_b128 v[24:27], v8 offset:4096
    ds_read_b64_tr_b16 v[56:57], v12 offset:8192
    ds_read_b64_tr_b16 v[58:59], v12 offset:8704
    ds_read_b128 v[28:31], v8 offset:6144
    ds_read_b64_tr_b16 v[60:61], v13 offset:8192
    ds_read_b64_tr_b16 v[62:63], v13 offset:8704
    ds_read_b128 v[32:35], v8 offset:8192
    ds_read_b128 v[36:39], v8 offset:10240
    ds_read_b128 v[40:43], v8 offset:12288
    ds_read_b128 v[44:47], v8 offset:14336
.p2align 3
L_cf_loop:
    s_waitcnt lgkmcnt(3)
    v_mfma_f32_16x16x32_bf16 v[128:131], v[48:51], v[16:19], v[128:131]
    ds_read_b64_tr_b16 v[64:65], v12 offset:4096
    v_mfma_f32_16x16x32_bf16 v[132:135], v[52:55], v[16:19], v[132:135]
    ds_read_b64_tr_b16 v[66:67], v12 offset:4608
    v_mfma_f32_16x16x32_bf16 v[136:139], v[56:59], v[16:19], v[136:139]
    v_mfma_f32_16x16x32_bf16 v[140:143], v[60:63], v[16:19], v[140:143]
    ds_read_b128 v[16:19], v9 offset:0
    v_mfma_f32_16x16x32_bf16 v[144:147], v[48:51], v[20:23], v[144:147]
    ds_read_b64_tr_b16 v[68:69], v13 offset:4096
    v_mfma_f32_16x16x32_bf16 v[148:151], v[52:55], v[20:23], v[148:151]
    ds_read_b64_tr_b16 v[70:71], v13 offset:4608
    v_mfma_f32_16x16x32_bf16 v[152:155], v[56:59], v[20:23], v[152:155]
    v_mfma_f32_16x16x32_bf16 v[156:159], v[60:63], v[20:23], v[156:159]
    ds_read_b128 v[20:23], v9 offset:2048
    v_mfma_f32_16x16x32_bf16 v[160:163], v[48:51], v[24:27], v[160:163]
    ds_read_b64_tr_b16 v[72:73], v12 offset:12288
    v_mfma_f32_16x16x32_bf16 v[164:167], v[52:55], v[24:27], v[164:167]
    ds_read_b64_tr_b16 v[74:75], v12 offset:12800
    v_mfma_f32_16x16x32_bf16 v[168:171], v[56:59], v[24:27], v[168:171]
    v_mfma_f32_16x16x32_bf16 v[172:175], v[60:63], v[24:27], v[172:175]
    ds_read_b128 v[24:27], v9 offset:4096
    v_mfma_f32_16x16x32_bf16 v[176:179], v[48:51], v[28:31], v[176:179]
    ds_read_b64_tr_b16 v[76:77], v13 offset:12288
    v_mfma_f32_16x16x32_bf16 v[180:183], v[52:55], v[28:31], v[180:183]
    ds_read_b64_tr_b16 v[78:79], v13 offset:12800
    v_mfma_f32_16x16x32_bf16 v[184:187], v[56:59], v[28:31], v[184:187]
    v_mfma_f32_16x16x32_bf16 v[188:191], v[60:63], v[28:31], v[188:191]
    ds_read_b128 v[28:31], v9 offset:6144
    s_waitcnt lgkmcnt(12)
    v_mfma_f32_16x16x32_bf16 v[192:195], v[48:51], v[32:35], v[192:195]
    s_add_u32 s61, s61, 1
    v_mfma_f32_16x16x32_bf16 v[196:199], v[52:55], v[32:35], v[196:199]
    s_cmp_eq_u32 s61, 3
    v_mfma_f32_16x16x32_bf16 v[200:203], v[56:59], v[32:35], v[200:203]
    s_cselect_b32 s62, -147456, 0
    v_mfma_f32_16x16x32_bf16 v[204:207], v[60:63], v[32:35], v[204:207]
    ds_read_b128 v[32:35], v9 offset:8192
    v_mfma_f32_16x16x32_bf16 v[208:211], v[48:51], v[36:39], v[208:211]
    s_cselect_b32 s61, 0, s61
    v_mfma_f32_16x16x32_bf16 v[212:215], v[52:55], v[36:39], v[212:215]
    s_add_u32 s62, s62, 49152
    v_mfma_f32_16x16x32_bf16 v[216:219], v[56:59], v[36:39], v[216:219]
    v_add_u32 v8, s62, v8
    v_mfma_f32_16x16x32_bf16 v[220:223], v[60:63], v[36:39], v[220:223]
    ds_read_b128 v[36:39], v9 offset:10240
    v_mfma_f32_16x16x32_bf16 v[224:227], v[48:51], v[40:43], v[224:227]
    v_add_u32 v12, s62, v12
    v_mfma_f32_16x16x32_bf16 v[228:231], v[52:55], v[40:43], v[228:231]
    v_add_u32 v13, s62, v13
    v_mfma_f32_16x16x32_bf16 v[232:235], v[56:59], v[40:43], v[232:235]
    s_sub_u32 s60, s60, 1
    v_mfma_f32_16x16x32_bf16 v[236:239], v[60:63], v[40:43], v[236:239]
    ds_read_b128 v[40:43], v9 offset:12288
    v_mfma_f32_16x16x32_bf16 v[240:243], v[48:51], v[44:47], v[240:243]
    v_mfma_f32_16x16x32_bf16 v[244:247], v[52:55], v[44:47], v[244:247]
    v_mfma_f32_16x16x32_bf16 v[248:251], v[56:59], v[44:47], v[248:251]
    v_mfma_f32_16x16x32_bf16 v[252:255], v[60:63], v[44:47], v[252:255]
    ds_read_b128 v[44:47], v9 offset:14336
    ds_read_b32 v122, v120 offset:12
    s_waitcnt lgkmcnt(5)
    v_mfma_f32_16x16x32_bf16 v[128:131], v[64:67], v[16:19], v[128:131]
    v_add_u32 v9, s62, v9
    v_mfma_f32_16x16x32_bf16 v[132:135], v[68:71], v[16:19], v[132:135]
    s_cmp_le_u32 s60, 1
    v_mfma_f32_16x16x32_bf16 v[136:139], v[72:75], v[16:19], v[136:139]
    v_mfma_f32_16x16x32_bf16 v[140:143], v[76:79], v[16:19], v[140:143]
    s_cbranch_scc1 L_cf_rel
    s_waitcnt vmcnt(0) lgkmcnt(0)
    s_barrier
L_cf_reld:
    ds_read_b128 v[16:19], v8 offset:0
    v_mfma_f32_16x16x32_bf16 v[144:147], v[64:67], v[20:23], v[144:147]
    ds_read_b64_tr_b16 v[48:49], v12 offset:0
    v_mfma_f32_16x16x32_bf16 v[148:151], v[68:71], v[20:23], v[148:151]
    ds_read_b64_tr_b16 v[50:51], v12 offset:512
    v_mfma_f32_16x16x32_bf16 v[152:155], v[72:75], v[20:23], v[152:155]
    v_mfma_f32_16x16x32_bf16 v[156:159], v[76:79], v[20:23], v[156:159]
    ds_read_b128 v[20:23], v8 offset:2048
    v_mfma_f32_16x16x32_bf16 v[160:163], v[64:67], v[24:27], v[160:163]
    ds_read_b64_tr_b16 v[52:53], v13 offset:0
    v_mfma_f32_16x16x32_bf16 v[164:167], v[68:71], v[24:27], v[164:167]
    ds_read_b64_tr_b16 v[54:55], v13 offset:512
    v_mfma_f32_16x16x32_bf16 v[168:171], v[72:75], v[24:27], v[168:171]
    v_mfma_f32_16x16x32_bf16 v[172:175], v[76:79], v[24:27], v[172:175]
    ds_read_b128 v[24:27], v8 offset:4096
    v_mfma_f32_16x16x32_bf16 v[176:179], v[64:67], v[28:31], v[176:179]
    ds_read_b64_tr_b16 v[56:57], v12 offset:8192
    v_mfma_f32_16x16x32_bf16 v[180:183], v[68:71], v[28:31], v[180:183]
    ds_read_b64_tr_b16 v[58:59], v12 offset:8704
    v_mfma_f32_16x16x32_bf16 v[184:187], v[72:75], v[28:31], v[184:187]
    v_mfma_f32_16x16x32_bf16 v[188:191], v[76:79], v[28:31], v[188:191]
    ds_read_b128 v[28:31], v8 offset:6144
    v_mfma_f32_16x16x32_bf16 v[192:195], v[64:67], v[32:35], v[192:195]
    ds_read_b64_tr_b16 v[60:61], v13 offset:8192
    v_mfma_f32_16x16x32_bf16 v[196:199], v[68:71], v[32:35], v[196:199]
    ds_read_b64_tr_b16 v[62:63], v13 offset:8704
    v_mfma_f32_16x16x32_bf16 v[200:203], v[72:75], v[32:35], v[200:203]
    v_mfma_f32_16x16x32_bf16 v[204:207], v[76:79], v[32:35], v[204:207]
    ds_read_b128 v[32:35], v8 offset:8192
    v_mfma_f32_16x16x32_bf16 v[208:211], v[64:67], v[36:39], v[208:211]
    v_mfma_f32_16x16x32_bf16 v[212:215], v[68:71], v[36:39], v[212:215]
    v_mfma_f32_16x16x32_bf16 v[216:219], v[72:75], v[36:39], v[216:219]
    v_mfma_f32_16x16x32_bf16 v[220:223], v[76:79], v[36:39], v[220:223]
    ds_read_b128 v[36:39], v8 offset:10240
    v_mfma_f32_16x16x32_bf16 v[224:227], v[64:67], v[40:43], v[224:227]
    v_mfma_f32_16x16x32_bf16 v[228:231], v[68:71], v[40:43], v[228:231]
    v_mfma_f32_16x16x32_bf16 v[232:235], v[72:75], v[40:43], v[232:235]
    v_mfma_f32_16x16x32_bf16 v[236:239], v[76:79], v[40:43], v[236:239]
    ds_read_b128 v[40:43], v8 offset:12288
    v_mfma_f32_16x16x32_bf16 v[240:243], v[64:67], v[44:47], v[240:243]
    v_mfma_f32_16x16x32_bf16 v[244:247], v[68:71], v[44:47], v[244:247]
    v_mfma_f32_16x16x32_bf16 v[248:251], v[72:75], v[44:47], v[248:251]
    s_cmp_lg_u32 s60, 1
    v_mfma_f32_16x16x32_bf16 v[252:255], v[76:79], v[44:47], v[252:255]
    ds_read_b128 v[44:47], v8 offset:14336
    s_cbranch_scc1 L_cf_loop
    s_branch L_cf_epi
L_cf_rel:
    s_mov_b32 s62, 0
    s_waitcnt lgkmcnt(0)
    s_mov_b64 exec, 1
    ds_add_u32 v120, v121 offset:4
    s_mov_b64 exec, -1
L_cf_land:
    v_cmp_gt_u32 vcc, 3, v122
    s_cbranch_vccz L_cf_reld
    ds_read_b32 v122, v120 offset:12
    s_add_u32 s62, s62, 1
    s_waitcnt lgkmcnt(0)
    s_cmp_lt_u32 s62, 0x400000
    s_cbranch_scc1 L_cf_land
    s_branch L_cf_reld
L_cf_epi:
    ds_read_b64_tr_b16 v[64:65], v12 offset:4096
    ds_read_b64_tr_b16 v[66:67], v12 offset:4608
    ds_read_b64_tr_b16 v[68:69], v13 offset:4096
    ds_read_b64_tr_b16 v[70:71], v13 offset:4608
    ds_read_b64_tr_b16 v[72:73], v12 offset:12288
    ds_read_b64_tr_b16 v[74:75], v12 offset:12800
    ds_read_b64_tr_b16 v[76:77], v13 offset:12288
    ds_read_b64_tr_b16 v[78:79], v13 offset:12800
    ds_read_b128 v[80:83], v9 offset:0
    s_waitcnt lgkmcnt(12)
    v_mfma_f32_16x16x32_bf16 v[128:131], v[48:51], v[16:19], v[128:131]
    v_mfma_f32_16x16x32_bf16 v[132:135], v[52:55], v[16:19], v[132:135]
    v_mfma_f32_16x16x32_bf16 v[136:139], v[56:59], v[16:19], v[136:139]
    v_mfma_f32_16x16x32_bf16 v[140:143], v[60:63], v[16:19], v[140:143]
    s_setprio 3
    s_mov_b32 s60, 0
L_cf_rdy:
    ds_read_b32 v122, v120 offset:8
    ds_read_b32 v123, v120 offset:20
    ds_read_b128 v[96:99], v4 offset:0
    ds_read_b128 v[100:103], v4 offset:64
    ds_read_b128 v[104:107], v4 offset:256
    ds_read_b128 v[108:111], v4 offset:320
    ds_read_b128 v[112:115], v5
    s_waitcnt lgkmcnt(0)
    v_cmp_eq_u32 vcc, 0, v122
    s_add_u32 s60, s60, 1
    s_cbranch_vccz L_cf_go
    s_cmp_lt_u32 s60, 0x400000
    s_cbranch_scc1 L_cf_rdy
L_cf_go:
    ds_read_b128 v[84:87], v9 offset:2048
    v_mfma_f32_16x16x32_bf16 v[128:131], v[64:67], v[80:83], v[128:131]
    v_mfma_f32_16x16x32_bf16 v[132:135], v[68:71], v[80:83], v[132:135]
    v_mfma_f32_16x16x32_bf16 v[136:139], v[72:75], v[80:83], v[136:139]
    v_mfma_f32_16x16x32_bf16 v[140:143], v[76:79], v[80:83], v[140:143]
    s_waitcnt lgkmcnt(0)
    ds_read_b128 v[116:119], v5 offset:256
    ds_read_b128 v[80:83], v9 offset:4096
    s_nop 4
    v_pk_fma_f32 v[128:129], v[96:97], v[112:113], v[128:129] op_sel_hi:[1,0,1]
    v_pk_fma_f32 v[130:131], v[98:99], v[112:113], v[130:131] op_sel_hi:[1,0,1]
    v_pk_fma_f32 v[132:133], v[100:101], v[112:113], v[132:133] op_sel_hi:[1,0,1]
    v_pk_fma_f32 v[134:135], v[102:103], v[112:113], v[134:135] op_sel_hi:[1,0,1]
    v_pk_mul_f32 v[88:89], v[128:129], v[128:129]
    v_pk_mul_f32 v[90:91], v[130:131], v[130:131]
    v_pk_mul_f32 v[92:93], v[132:133], v[132:133]
    v_pk_mul_f32 v[94:95], v[134:135], v[134:135]
    v_pk_fma_f32 v[88:89], v[88:89], v[114:115], v[112:113] op_sel:[0,0,1] op_sel_hi:[1,0,1]
    v_pk_fma_f32 v[90:91], v[90:91], v[114:115], v[112:113] op_sel:[0,0,1] op_sel_hi:[1,0,1]
    v_pk_fma_f32 v[92:93], v[92:93], v[114:115], v[112:113] op_sel:[0,0,1] op_sel_hi:[1,0,1]
    v_pk_fma_f32 v[94:95], v[94:95], v[114:115], v[112:113] op_sel:[0,0,1] op_sel_hi:[1,0,1]
    v_pk_mul_f32 v[88:89], v[88:89], v[128:129]
    v_pk_mul_f32 v[90:91], v[90:91], v[130:131]
    v_pk_mul_f32 v[92:93], v[92:93], v[132:133]
    v_pk_mul_f32 v[94:95], v[94:95], v[134:135]
    v_pk_fma_f32 v[136:137], v[104:105], v[112:113], v[136:137] op_sel_hi:[1,0,1]
    v_pk_fma_f32 v[138:139], v[106:107], v[112:113], v[138:139] op_sel_hi:[1,0,1]
    v_pk_fma_f32 v[140:141], v[108:109], v[112:113], v[140:141] op_sel_hi:[1,0,1]
    v_pk_fma_f32 v[142:143], v[110:111], v[112:113], v[142:143] op_sel_hi:[1,0,1]
    v_pk_mul_f32 v[136:137], v[136:137], v[128:129]
    v_pk_mul_f32 v[138:139], v[138:139], v[130:131]
    v_pk_mul_f32 v[140:141], v[140:141], v[132:133]
    v_pk_mul_f32 v[142:143], v[142:143], v[134:135]
    v_mfma_f32_16x16x32_bf16 v[144:147], v[48:51], v[20:23], v[144:147]
    v_exp_f32 v88, v88
    v_exp_f32 v89, v89
    v_mfma_f32_16x16x32_bf16 v[148:151], v[52:55], v[20:23], v[148:151]
    v_exp_f32 v90, v90
    v_exp_f32 v91, v91
    v_mfma_f32_16x16x32_bf16 v[152:155], v[56:59], v[20:23], v[152:155]
    v_exp_f32 v92, v92
    v_exp_f32 v93, v93
    v_mfma_f32_16x16x32_bf16 v[156:159], v[60:63], v[20:23], v[156:159]
    v_exp_f32 v94, v94
    v_exp_f32 v95, v95
    v_fma_f32 v88, v88, v115, v115
    v_fma_f32 v89, v89, v115, v115
    v_fma_f32 v90, v90, v115, v115
    v_fma_f32 v91, v91, v115, v115
    v_fma_f32 v92, v92, v115, v115
    v_fma_f32 v93, v93, v115, v115
    v_fma_f32 v94, v94, v115, v115
    v_fma_f32 v95, v95, v115, v115
    v_mfma_f32_16x16x32_bf16 v[144:147], v[64:67], v[84:87], v[144:147]
    v_rcp_f32 v88, v88
    v_rcp_f32 v89, v89
    v_mfma_f32_16x16x32_bf16 v[148:151], v[68:71], v[84:87], v[148:151]
    v_rcp_f32 v90, v90
    v_rcp_f32 v91, v91
    v_mfma_f32_16x16x32_bf16 v[152:155], v[72:75], v[84:87], v[152:155]
    v_rcp_f32 v92, v92
    v_rcp_f32 v93, v93
    v_mfma_f32_16x16x32_bf16 v[156:159], v[76:79], v[84:87], v[156:159]
    v_rcp_f32 v94, v94
    v_rcp_f32 v95, v95
    v_pk_mul_f32 v[136:137], v[136:137], v[88:89]
    v_pk_mul_f32 v[138:139], v[138:139], v[90:91]
    v_pk_mul_f32 v[140:141], v[140:141], v[92:93]
    v_pk_mul_f32 v[142:143], v[142:143], v[94:95]
    v_cvt_pk_bf16_f32 v128, v136, v137
    v_cvt_pk_bf16_f32 v129, v138, v139
    v_cvt_pk_bf16_f32 v130, v140, v141
    v_cvt_pk_bf16_f32 v131, v142, v143
    buffer_store_dwordx4 v[128:131], v6, s[16:19], s50 offen offset:0 sc1
    s_waitcnt lgkmcnt(0)
    ds_read_b128 v[112:115], v5 offset:512
    ds_read_b128 v[84:87], v9 offset:6144
    v_pk_fma_f32 v[144:145], v[96:97], v[116:117], v[144:145] op_sel_hi:[1,0,1]
    v_pk_fma_f32 v[146:147], v[98:99], v[116:117], v[146:147] op_sel_hi:[1,0,1]
    v_pk_fma_f32 v[148:149], v[100:101], v[116:117], v[148:149] op_sel_hi:[1,0,1]
    v_pk_fma_f32 v[150:151], v[102:103], v[116:117], v[150:151] op_sel_hi:[1,0,1]
    v_pk_mul_f32 v[88:89], v[144:145], v[144:145]
    v_pk_mul_f32 v[90:91], v[146:147], v[146:147]
    v_pk_mul_f32 v[92:93], v[148:149], v[148:149]
    v_pk_mul_f32 v[94:95], v[150:151], v[150:151]
    v_pk_fma_f32 v[88:89], v[88:89], v[118:119], v[116:117] op_sel:[0,0,1] op_sel_hi:[1,0,1]
    v_pk_fma_f32 v[90:91], v[90:91], v[118:119], v[116:117] op_sel:[0,0,1] op_sel_hi:[1,0,1]
    v_pk_fma_f32 v[92:93], v[92:93], v[118:119], v[116:117] op_sel:[0,0,1] op_sel_hi:[1,0,1]
    v_pk_fma_f32 v[94:95], v[94:95], v[118:119], v[116:117] op_sel:[0,0,1] op_sel_hi:[1,0,1]
    v_pk_mul_f32 v[88:89], v[88:89], v[144:145]
    v_pk_mul_f32 v[90:91], v[90:91], v[146:147]
    v_pk_mul_f32 v[92:93], v[92:93], v[148:149]
    v_pk_mul_f32 v[94:95], v[94:95], v[150:151]
    v_pk_fma_f32 v[152:153], v[104:105], v[116:117], v[152:153] op_sel_hi:[1,0,1]
    v_pk_fma_f32 v[154:155], v[106:107], v[116:117], v[154:155] op_sel_hi:[1,0,1]
    v_pk_fma_f32 v[156:157], v[108:109], v[116:117], v[156:157] op_sel_hi:[1,0,1]
    v_pk_fma_f32 v[158:159], v[110:111], v[116:117], v[158:159] op_sel_hi:[1,0,1]
    v_pk_mul_f32 v[152:153], v[152:153], v[144:145]
    v_pk_mul_f32 v[154:155], v[154:155], v[146:147]
    v_pk_mul_f32 v[156:157], v[156:157], v[148:149]
    v_pk_mul_f32 v[158:159], v[158:159], v[150:151]
    v_mfma_f32_16x16x32_bf16 v[160:163], v[48:51], v[24:27], v[160:163]
    v_exp_f32 v88, v88
    v_exp_f32 v89, v89
    v_mfma_f32_16x16x32_bf16 v[164:167], v[52:55], v[24:27], v[164:167]
    v_exp_f32 v90, v90
    v_exp_f32 v91, v91
    v_mfma_f32_16x16x32_bf16 v[168:171], v[56:59], v[24:27], v[168:171]
    v_exp_f32 v92, v92
    v_exp_f32 v93, v93
    v_mfma_f32_16x16x32_bf16 v[172:175], v[60:63], v[24:27], v[172:175]
    v_exp_f32 v94, v94
    v_exp_f32 v95, v95
    v_fma_f32 v88, v88, v119, v119
    v_fma_f32 v89, v89, v119, v119
    v_fma_f32 v90, v90, v119, v119
    v_fma_f32 v91, v91, v119, v119
    v_fma_f32 v92, v92, v119, v119
    v_fma_f32 v93, v93, v119, v119
    v_fma_f32 v94, v94, v119, v119
    v_fma_f32 v95, v95, v119, v119
    v_mfma_f32_16x16x32_bf16 v[160:163], v[64:67], v[80:83], v[160:163]
    v_rcp_f32 v88, v88
    v_rcp_f32 v89, v89
    v_mfma_f32_16x16x32_bf16 v[164:167], v[68:71], v[80:83], v[164:167]
    v_rcp_f32 v90, v90
    v_rcp_f32 v91, v91
    v_mfma_f32_16x16x32_bf16 v[168:171], v[72:75], v[80:83], v[168:171]
    v_rcp_f32 v92, v92
    v_rcp_f32 v93, v93
    v_mfma_f32_16x16x32_bf16 v[172:175], v[76:79], v[80:83], v[172:175]
    v_rcp_f32 v94, v94
    v_rcp_f32 v95, v95
    v_pk_mul_f32 v[152:153], v[152:153], v[88:89]
    v_pk_mul_f32 v[154:155], v[154:155], v[90:91]
    v_pk_mul_f32 v[156:157], v[156:157], v[92:93]
    v_pk_mul_f32 v[158:159], v[158:159], v[94:95]
    v_cvt_pk_bf16_f32 v144, v152, v153
    v_cvt_pk_bf16_f32 v145, v154, v155
    v_cvt_pk_bf16_f32 v146, v156, v157
    v_cvt_pk_bf16_f32 v147, v158, v159
    buffer_store_dwordx4 v[144:147], v6, s[16:19], s50 offen offset:1024 sc1
    s_add_u32 s50, s50, 4096
    s_waitcnt lgkmcnt(0)
    ds_read_b128 v[116:119], v5 offset:768
    ds_read_b128 v[80:83], v9 offset:8192
    v_pk_fma_f32 v[160:161], v[96:97], v[112:113], v[160:161] op_sel_hi:[1,0,1]
    v_pk_fma_f32 v[162:163], v[98:99], v[112:113], v[162:163] op_sel_hi:[1,0,1]
    v_pk_fma_f32 v[164:165], v[100:101], v[112:113], v[164:165] op_sel_hi:[1,0,1]
    v_pk_fma_f32 v[166:167], v[102:103], v[112:113], v[166:167] op_sel_hi:[1,0,1]
    v_pk_mul_f32 v[88:89], v[160:161], v[160:161]
    v_pk_mul_f32 v[90:91], v[162:163], v[162:163]
    v_pk_mul_f32 v[92:93], v[164:165], v[164:165]
    v_pk_mul_f32 v[94:95], v[166:167], v[166:167]
    v_pk_fma_f32 v[88:89], v[88:89], v[114:115], v[112:113] op_sel:[0,0,1] op_sel_hi:[1,0,1]
    v_pk_fma_f32 v[90:91], v[90:91], v[114:115], v[112:113] op_sel:[0,0,1] op_sel_hi:[1,0,1]
    v_pk_fma_f32 v[92:93], v[92:93], v[114:115], v[112:113] op_sel:[0,0,1] op_sel_hi:[1,0,1]
    v_pk_fma_f32 v[94:95], v[94:95], v[114:115], v[112:113] op_sel:[0,0,1] op_sel_hi:[1,0,1]
    v_pk_mul_f32 v[88:89], v[88:89], v[160:161]
    v_pk_mul_f32 v[90:91], v[90:91], v[162:163]
    v_pk_mul_f32 v[92:93], v[92:93], v[164:165]
    v_pk_mul_f32 v[94:95], v[94:95], v[166:167]
    v_pk_fma_f32 v[168:169], v[104:105], v[112:113], v[168:169] op_sel_hi:[1,0,1]
    v_pk_fma_f32 v[170:171], v[106:107], v[112:113], v[170:171] op_sel_hi:[1,0,1]
    v_pk_fma_f32 v[172:173], v[108:109], v[112:113], v[172:173] op_sel_hi:[1,0,1]
    v_pk_fma_f32 v[174:175], v[110:111], v[112:113], v[174:175] op_sel_hi:[1,0,1]
    v_pk_mul_f32 v[168:169], v[168:169], v[160:161]
    v_pk_mul_f32 v[170:171], v[170:171], v[162:163]
    v_pk_mul_f32 v[172:173], v[172:173], v[164:165]
    v_pk_mul_f32 v[174:175], v[174:175], v[166:167]
    v_mfma_f32_16x16x32_bf16 v[176:179], v[48:51], v[28:31], v[176:179]
    v_exp_f32 v88, v88
    v_exp_f32 v89, v89
    v_mfma_f32_16x16x32_bf16 v[180:183], v[52:55], v[28:31], v[180:183]
    v_exp_f32 v90, v90
    v_exp_f32 v91, v91
    v_mfma_f32_16x16x32_bf16 v[184:187], v[56:59], v[28:31], v[184:187]
    v_exp_f32 v92, v92
    v_exp_f32 v93, v93
    v_mfma_f32_16x16x32_bf16 v[188:191], v[60:63], v[28:31], v[188:191]
    v_exp_f32 v94, v94
    v_exp_f32 v95, v95
    v_fma_f32 v88, v88, v115, v115
    v_fma_f32 v89, v89, v115, v115
    v_fma_f32 v90, v90, v115, v115
    v_fma_f32 v91, v91, v115, v115
    v_fma_f32 v92, v92, v115, v115
    v_fma_f32 v93, v93, v115, v115
    v_fma_f32 v94, v94, v115, v115
    v_fma_f32 v95, v95, v115, v115
    v_mfma_f32_16x16x32_bf16 v[176:179], v[64:67], v[84:87], v[176:179]
    v_rcp_f32 v88, v88
    v_rcp_f32 v89, v89
    v_mfma_f32_16x16x32_bf16 v[180:183], v[68:71], v[84:87], v[180:183]
    v_rcp_f32 v90, v90
    v_rcp_f32 v91, v91
    v_mfma_f32_16x16x32_bf16 v[184:187], v[72:75], v[84:87], v[184:187]
    v_rcp_f32 v92, v92
    v_rcp_f32 v93, v93
    v_mfma_f32_16x16x32_bf16 v[188:191], v[76:79], v[84:87], v[188:191]
    v_rcp_f32 v94, v94
    v_rcp_f32 v95, v95
    v_pk_mul_f32 v[168:169], v[168:169], v[88:89]
    v_pk_mul_f32 v[170:171], v[170:171], v[90:91]
    v_pk_mul_f32 v[172:173], v[172:173], v[92:93]
    v_pk_mul_f32 v[174:175], v[174:175], v[94:95]
    v_cvt_pk_bf16_f32 v160, v168, v169
    v_cvt_pk_bf16_f32 v161, v170, v171
    v_cvt_pk_bf16_f32 v162, v172, v173
    v_cvt_pk_bf16_f32 v163, v174, v175
    buffer_store_dwordx4 v[160:163], v6, s[16:19], s50 offen offset:0 sc1
    s_waitcnt lgkmcnt(0)
    ds_read_b128 v[112:115], v5 offset:1024
    ds_read_b128 v[84:87], v9 offset:10240
    v_pk_fma_f32 v[176:177], v[96:97], v[116:117], v[176:177] op_sel_hi:[1,0,1]
    v_pk_fma_f32 v[178:179], v[98:99], v[116:117], v[178:179] op_sel_hi:[1,0,1]
    v_pk_fma_f32 v[180:181], v[100:101], v[116:117], v[180:181] op_sel_hi:[1,0,1]
    v_pk_fma_f32 v[182:183], v[102:103], v[116:117], v[182:183] op_sel_hi:[1,0,1]
    v_pk_mul_f32 v[88:89], v[176:177], v[176:177]
    v_pk_mul_f32 v[90:91], v[178:179], v[178:179]
    v_pk_mul_f32 v[92:93], v[180:181], v[180:181]
    v_pk_mul_f32 v[94:95], v[182:183], v[182:183]
    v_pk_fma_f32 v[88:89], v[88:89], v[118:119], v[116:117] op_sel:[0,0,1] op_sel_hi:[1,0,1]
    v_pk_fma_f32 v[90:91], v[90:91], v[118:119], v[116:117] op_sel:[0,0,1] op_sel_hi:[1,0,1]
    v_pk_fma_f32 v[92:93], v[92:93], v[118:119], v[116:117] op_sel:[0,0,1] op_sel_hi:[1,0,1]
    v_pk_fma_f32 v[94:95], v[94:95], v[118:119], v[116:117] op_sel:[0,0,1] op_sel_hi:[1,0,1]
    v_pk_mul_f32 v[88:89], v[88:89], v[176:177]
    v_pk_mul_f32 v[90:91], v[90:91], v[178:179]
    v_pk_mul_f32 v[92:93], v[92:93], v[180:181]
    v_pk_mul_f32 v[94:95], v[94:95], v[182:183]
    v_pk_fma_f32 v[184:185], v[104:105], v[116:117], v[184:185] op_sel_hi:[1,0,1]
    v_pk_fma_f32 v[186:187], v[106:107], v[116:117], v[186:187] op_sel_hi:[1,0,1]
    v_pk_fma_f32 v[188:189], v[108:109], v[116:117], v[188:189] op_sel_hi:[1,0,1]
    v_pk_fma_f32 v[190:191], v[110:111], v[116:117], v[190:191] op_sel_hi:[1,0,1]
    v_pk_mul_f32 v[184:185], v[184:185], v[176:177]
    v_pk_mul_f32 v[186:187], v[186:187], v[178:179]
    v_pk_mul_f32 v[188:189], v[188:189], v[180:181]
    v_pk_mul_f32 v[190:191], v[190:191], v[182:183]
    v_mfma_f32_16x16x32_bf16 v[192:195], v[48:51], v[32:35], v[192:195]
    v_exp_f32 v88, v88
    v_exp_f32 v89, v89
    v_mfma_f32_16x16x32_bf16 v[196:199], v[52:55], v[32:35], v[196:199]
    v_exp_f32 v90, v90
    v_exp_f32 v91, v91
    v_mfma_f32_16x16x32_bf16 v[200:203], v[56:59], v[32:35], v[200:203]
    v_exp_f32 v92, v92
    v_exp_f32 v93, v93
    v_mfma_f32_16x16x32_bf16 v[204:207], v[60:63], v[32:35], v[204:207]
    v_exp_f32 v94, v94
    v_exp_f32 v95, v95
    v_fma_f32 v88, v88, v119, v119
    v_fma_f32 v89, v89, v119, v119
    v_fma_f32 v90, v90, v119, v119
    v_fma_f32 v91, v91, v119, v119
    v_fma_f32 v92, v92, v119, v119
    v_fma_f32 v93, v93, v119, v119
    v_fma_f32 v94, v94, v119, v119
    v_fma_f32 v95, v95, v119, v119
    v_mfma_f32_16x16x32_bf16 v[192:195], v[64:67], v[80:83], v[192:195]
    v_rcp_f32 v88, v88
    v_rcp_f32 v89, v89
    v_mfma_f32_16x16x32_bf16 v[196:199], v[68:71], v[80:83], v[196:199]
    v_rcp_f32 v90, v90
    v_rcp_f32 v91, v91
    v_mfma_f32_16x16x32_bf16 v[200:203], v[72:75], v[80:83], v[200:203]
    v_rcp_f32 v92, v92
    v_rcp_f32 v93, v93
    v_mfma_f32_16x16x32_bf16 v[204:207], v[76:79], v[80:83], v[204:207]
    v_rcp_f32 v94, v94
    v_rcp_f32 v95, v95
    v_pk_mul_f32 v[184:185], v[184:185], v[88:89]
    v_pk_mul_f32 v[186:187], v[186:187], v[90:91]
    v_pk_mul_f32 v[188:189], v[188:189], v[92:93]
    v_pk_mul_f32 v[190:191], v[190:191], v[94:95]
    v_cvt_pk_bf16_f32 v176, v184, v185
    v_cvt_pk_bf16_f32 v177, v186, v187
    v_cvt_pk_bf16_f32 v178, v188, v189
    v_cvt_pk_bf16_f32 v179, v190, v191
    buffer_store_dwordx4 v[176:179], v6, s[16:19], s50 offen offset:1024 sc1
    s_add_u32 s50, s50, 4096
    s_waitcnt lgkmcnt(0)
    ds_read_b128 v[116:119], v5 offset:1280
    ds_read_b128 v[80:83], v9 offset:12288
    v_pk_fma_f32 v[192:193], v[96:97], v[112:113], v[192:193] op_sel_hi:[1,0,1]
    v_pk_fma_f32 v[194:195], v[98:99], v[112:113], v[194:195] op_sel_hi:[1,0,1]
    v_pk_fma_f32 v[196:197], v[100:101], v[112:113], v[196:197] op_sel_hi:[1,0,1]
    v_pk_fma_f32 v[198:199], v[102:103], v[112:113], v[198:199] op_sel_hi:[1,0,1]
    v_pk_mul_f32 v[88:89], v[192:193], v[192:193]
    v_pk_mul_f32 v[90:91], v[194:195], v[194:195]
    v_pk_mul_f32 v[92:93], v[196:197], v[196:197]
    v_pk_mul_f32 v[94:95], v[198:199], v[198:199]
    v_pk_fma_f32 v[88:89], v[88:89], v[114:115], v[112:113] op_sel:[0,0,1] op_sel_hi:[1,0,1]
    v_pk_fma_f32 v[90:91], v[90:91], v[114:115], v[112:113] op_sel:[0,0,1] op_sel_hi:[1,0,1]
    v_pk_fma_f32 v[92:93], v[92:93], v[114:115], v[112:113] op_sel:[0,0,1] op_sel_hi:[1,0,1]
    v_pk_fma_f32 v[94:95], v[94:95], v[114:115], v[112:113] op_sel:[0,0,1] op_sel_hi:[1,0,1]
    v_pk_mul_f32 v[88:89], v[88:89], v[192:193]
    v_pk_mul_f32 v[90:91], v[90:91], v[194:195]
    v_pk_mul_f32 v[92:93], v[92:93], v[196:197]
    v_pk_mul_f32 v[94:95], v[94:95], v[198:199]
    v_pk_fma_f32 v[200:201], v[104:105], v[112:113], v[200:201] op_sel_hi:[1,0,1]
    v_pk_fma_f32 v[202:203], v[106:107], v[112:113], v[202:203] op_sel_hi:[1,0,1]
    v_pk_fma_f32 v[204:205], v[108:109], v[112:113], v[204:205] op_sel_hi:[1,0,1]
    v_pk_fma_f32 v[206:207], v[110:111], v[112:113], v[206:207] op_sel_hi:[1,0,1]
    v_pk_mul_f32 v[200:201], v[200:201], v[192:193]
    v_pk_mul_f32 v[202:203], v[202:203], v[194:195]
    v_pk_mul_f32 v[204:205], v[204:205], v[196:197]
    v_pk_mul_f32 v[206:207], v[206:207], v[198:199]
    v_mfma_f32_16x16x32_bf16 v[208:211], v[48:51], v[36:39], v[208:211]
    v_exp_f32 v88, v88
    v_exp_f32 v89, v89
    v_mfma_f32_16x16x32_bf16 v[212:215], v[52:55], v[36:39], v[212:215]
    v_exp_f32 v90, v90
    v_exp_f32 v91, v91
    v_mfma_f32_16x16x32_bf16 v[216:219], v[56:59], v[36:39], v[216:219]
    v_exp_f32 v92, v92
    v_exp_f32 v93, v93
    v_mfma_f32_16x16x32_bf16 v[220:223], v[60:63], v[36:39], v[220:223]
    v_exp_f32 v94, v94
    v_exp_f32 v95, v95
    v_fma_f32 v88, v88, v115, v115
    v_fma_f32 v89, v89, v115, v115
    v_fma_f32 v90, v90, v115, v115
    v_fma_f32 v91, v91, v115, v115
    v_fma_f32 v92, v92, v115, v115
    v_fma_f32 v93, v93, v115, v115
    v_fma_f32 v94, v94, v115, v115
    v_fma_f32 v95, v95, v115, v115
    v_mfma_f32_16x16x32_bf16 v[208:211], v[64:67], v[84:87], v[208:211]
    v_rcp_f32 v88, v88
    v_rcp_f32 v89, v89
    v_mfma_f32_16x16x32_bf16 v[212:215], v[68:71], v[84:87], v[212:215]
    v_rcp_f32 v90, v90
    v_rcp_f32 v91, v91
    v_mfma_f32_16x16x32_bf16 v[216:219], v[72:75], v[84:87], v[216:219]
    v_rcp_f32 v92, v92
    v_rcp_f32 v93, v93
    v_mfma_f32_16x16x32_bf16 v[220:223], v[76:79], v[84:87], v[220:223]
    v_rcp_f32 v94, v94
    v_rcp_f32 v95, v95
    v_pk_mul_f32 v[200:201], v[200:201], v[88:89]
    v_pk_mul_f32 v[202:203], v[202:203], v[90:91]
    v_pk_mul_f32 v[204:205], v[204:205], v[92:93]
    v_pk_mul_f32 v[206:207], v[206:207], v[94:95]
    v_cvt_pk_bf16_f32 v192, v200, v201
    v_cvt_pk_bf16_f32 v193, v202, v203
    v_cvt_pk_bf16_f32 v194, v204, v205
    v_cvt_pk_bf16_f32 v195, v206, v207
    buffer_store_dwordx4 v[192:195], v6, s[16:19], s50 offen offset:0 sc1
    s_waitcnt lgkmcnt(0)
    ds_read_b128 v[112:115], v5 offset:1536
    ds_read_b128 v[84:87], v9 offset:14336
    v_pk_fma_f32 v[208:209], v[96:97], v[116:117], v[208:209] op_sel_hi:[1,0,1]
    v_pk_fma_f32 v[210:211], v[98:99], v[116:117], v[210:211] op_sel_hi:[1,0,1]
    v_pk_fma_f32 v[212:213], v[100:101], v[116:117], v[212:213] op_sel_hi:[1,0,1]
    v_pk_fma_f32 v[214:215], v[102:103], v[116:117], v[214:215] op_sel_hi:[1,0,1]
    v_pk_mul_f32 v[88:89], v[208:209], v[208:209]
    v_pk_mul_f32 v[90:91], v[210:211], v[210:211]
    v_pk_mul_f32 v[92:93], v[212:213], v[212:213]
    v_pk_mul_f32 v[94:95], v[214:215], v[214:215]
    v_pk_fma_f32 v[88:89], v[88:89], v[118:119], v[116:117] op_sel:[0,0,1] op_sel_hi:[1,0,1]
    v_pk_fma_f32 v[90:91], v[90:91], v[118:119], v[116:117] op_sel:[0,0,1] op_sel_hi:[1,0,1]
    v_pk_fma_f32 v[92:93], v[92:93], v[118:119], v[116:117] op_sel:[0,0,1] op_sel_hi:[1,0,1]
    v_pk_fma_f32 v[94:95], v[94:95], v[118:119], v[116:117] op_sel:[0,0,1] op_sel_hi:[1,0,1]
    v_pk_mul_f32 v[88:89], v[88:89], v[208:209]
    v_pk_mul_f32 v[90:91], v[90:91], v[210:211]
    v_pk_mul_f32 v[92:93], v[92:93], v[212:213]
    v_pk_mul_f32 v[94:95], v[94:95], v[214:215]
    v_pk_fma_f32 v[216:217], v[104:105], v[116:117], v[216:217] op_sel_hi:[1,0,1]
    v_pk_fma_f32 v[218:219], v[106:107], v[116:117], v[218:219] op_sel_hi:[1,0,1]
    v_pk_fma_f32 v[220:221], v[108:109], v[116:117], v[220:221] op_sel_hi:[1,0,1]
    v_pk_fma_f32 v[222:223], v[110:111], v[116:117], v[222:223] op_sel_hi:[1,0,1]
    v_pk_mul_f32 v[216:217], v[216:217], v[208:209]
    v_pk_mul_f32 v[218:219], v[218:219], v[210:211]
    v_pk_mul_f32 v[220:221], v[220:221], v[212:213]
    v_pk_mul_f32 v[222:223], v[222:223], v[214:215]
    v_mfma_f32_16x16x32_bf16 v[224:227], v[48:51], v[40:43], v[224:227]
    v_exp_f32 v88, v88
    v_exp_f32 v89, v89
    v_mfma_f32_16x16x32_bf16 v[228:231], v[52:55], v[40:43], v[228:231]
    v_exp_f32 v90, v90
    v_exp_f32 v91, v91
    v_mfma_f32_16x16x32_bf16 v[232:235], v[56:59], v[40:43], v[232:235]
    v_exp_f32 v92, v92
    v_exp_f32 v93, v93
    v_mfma_f32_16x16x32_bf16 v[236:239], v[60:63], v[40:43], v[236:239]
    v_exp_f32 v94, v94
    v_exp_f32 v95, v95
    v_fma_f32 v88, v88, v119, v119
    v_fma_f32 v89, v89, v119, v119
    v_fma_f32 v90, v90, v119, v119
    v_fma_f32 v91, v91, v119, v119
    v_fma_f32 v92, v92, v119, v119
    v_fma_f32 v93, v93, v119, v119
    v_fma_f32 v94, v94, v119, v119
    v_fma_f32 v95, v95, v119, v119
    v_mfma_f32_16x16x32_bf16 v[224:227], v[64:67], v[80:83], v[224:227]
    v_rcp_f32 v88, v88
    v_rcp_f32 v89, v89
    v_mfma_f32_16x16x32_bf16 v[228:231], v[68:71], v[80:83], v[228:231]
    v_rcp_f32 v90, v90
    v_rcp_f32 v91, v91
    v_mfma_f32_16x16x32_bf16 v[232:235], v[72:75], v[80:83], v[232:235]
    v_rcp_f32 v92, v92
    v_rcp_f32 v93, v93
    v_mfma_f32_16x16x32_bf16 v[236:239], v[76:79], v[80:83], v[236:239]
    v_rcp_f32 v94, v94
    v_rcp_f32 v95, v95
    v_pk_mul_f32 v[216:217], v[216:217], v[88:89]
    v_pk_mul_f32 v[218:219], v[218:219], v[90:91]
    v_pk_mul_f32 v[220:221], v[220:221], v[92:93]
    v_pk_mul_f32 v[222:223], v[222:223], v[94:95]
    v_cvt_pk_bf16_f32 v208, v216, v217
    v_cvt_pk_bf16_f32 v209, v218, v219
    v_cvt_pk_bf16_f32 v210, v220, v221
    v_cvt_pk_bf16_f32 v211, v222, v223
    buffer_store_dwordx4 v[208:211], v6, s[16:19], s50 offen offset:1024 sc1
    s_add_u32 s50, s50, 4096
    s_waitcnt lgkmcnt(0)
    ds_read_b128 v[116:119], v5 offset:1792
    s_mov_b64 exec, 1
    ds_add_u32 v120, v121 offset:4
    s_mov_b64 exec, -1
    v_pk_fma_f32 v[224:225], v[96:97], v[112:113], v[224:225] op_sel_hi:[1,0,1]
    v_pk_fma_f32 v[226:227], v[98:99], v[112:113], v[226:227] op_sel_hi:[1,0,1]
    v_pk_fma_f32 v[228:229], v[100:101], v[112:113], v[228:229] op_sel_hi:[1,0,1]
    v_pk_fma_f32 v[230:231], v[102:103], v[112:113], v[230:231] op_sel_hi:[1,0,1]
    v_pk_mul_f32 v[88:89], v[224:225], v[224:225]
    v_pk_mul_f32 v[90:91], v[226:227], v[226:227]
    v_pk_mul_f32 v[92:93], v[228:229], v[228:229]
    v_pk_mul_f32 v[94:95], v[230:231], v[230:231]
    v_pk_fma_f32 v[88:89], v[88:89], v[114:115], v[112:113] op_sel:[0,0,1] op_sel_hi:[1,0,1]
    v_pk_fma_f32 v[90:91], v[90:91], v[114:115], v[112:113] op_sel:[0,0,1] op_sel_hi:[1,0,1]
    v_pk_fma_f32 v[92:93], v[92:93], v[114:115], v[112:113] op_sel:[0,0,1] op_sel_hi:[1,0,1]
    v_pk_fma_f32 v[94:95], v[94:95], v[114:115], v[112:113] op_sel:[0,0,1] op_sel_hi:[1,0,1]
    v_pk_mul_f32 v[88:89], v[88:89], v[224:225]
    v_pk_mul_f32 v[90:91], v[90:91], v[226:227]
    v_pk_mul_f32 v[92:93], v[92:93], v[228:229]
    v_pk_mul_f32 v[94:95], v[94:95], v[230:231]
    v_pk_fma_f32 v[232:233], v[104:105], v[112:113], v[232:233] op_sel_hi:[1,0,1]
    v_pk_fma_f32 v[234:235], v[106:107], v[112:113], v[234:235] op_sel_hi:[1,0,1]
    v_pk_fma_f32 v[236:237], v[108:109], v[112:113], v[236:237] op_sel_hi:[1,0,1]
    v_pk_fma_f32 v[238:239], v[110:111], v[112:113], v[238:239] op_sel_hi:[1,0,1]
    v_pk_mul_f32 v[232:233], v[232:233], v[224:225]
    v_pk_mul_f32 v[234:235], v[234:235], v[226:227]
    v_pk_mul_f32 v[236:237], v[236:237], v[228:229]
    v_pk_mul_f32 v[238:239], v[238:239], v[230:231]
    v_mfma_f32_16x16x32_bf16 v[240:243], v[48:51], v[44:47], v[240:243]
    v_exp_f32 v88, v88
    v_exp_f32 v89, v89
    v_mfma_f32_16x16x32_bf16 v[244:247], v[52:55], v[44:47], v[244:247]
    v_exp_f32 v90, v90
    v_exp_f32 v91, v91
    v_mfma_f32_16x16x32_bf16 v[248:251], v[56:59], v[44:47], v[248:251]
    v_exp_f32 v92, v92
    v_exp_f32 v93, v93
    v_mfma_f32_16x16x32_bf16 v[252:255], v[60:63], v[44:47], v[252:255]
    v_exp_f32 v94, v94
    v_exp_f32 v95, v95
    v_fma_f32 v88, v88, v115, v115
    v_fma_f32 v89, v89, v115, v115
    v_fma_f32 v90, v90, v115, v115
    v_fma_f32 v91, v91, v115, v115
    v_fma_f32 v92, v92, v115, v115
    v_fma_f32 v93, v93, v115, v115
    v_fma_f32 v94, v94, v115, v115
    v_fma_f32 v95, v95, v115, v115
    v_mfma_f32_16x16x32_bf16 v[240:243], v[64:67], v[84:87], v[240:243]
    v_rcp_f32 v88, v88
    v_rcp_f32 v89, v89
    v_mfma_f32_16x16x32_bf16 v[244:247], v[68:71], v[84:87], v[244:247]
    v_rcp_f32 v90, v90
    v_rcp_f32 v91, v91
    v_mfma_f32_16x16x32_bf16 v[248:251], v[72:75], v[84:87], v[248:251]
    v_rcp_f32 v92, v92
    v_rcp_f32 v93, v93
    v_mfma_f32_16x16x32_bf16 v[252:255], v[76:79], v[84:87], v[252:255]
    v_rcp_f32 v94, v94
    v_rcp_f32 v95, v95
    v_pk_mul_f32 v[232:233], v[232:233], v[88:89]
    v_pk_mul_f32 v[234:235], v[234:235], v[90:91]
    v_pk_mul_f32 v[236:237], v[236:237], v[92:93]
    v_pk_mul_f32 v[238:239], v[238:239], v[94:95]
    v_cvt_pk_bf16_f32 v224, v232, v233
    v_cvt_pk_bf16_f32 v225, v234, v235
    v_cvt_pk_bf16_f32 v226, v236, v237
    v_cvt_pk_bf16_f32 v227, v238, v239
    buffer_store_dwordx4 v[224:227], v6, s[16:19], s50 offen offset:0 sc1
    s_waitcnt lgkmcnt(0)
    v_pk_fma_f32 v[240:241], v[96:97], v[116:117], v[240:241] op_sel_hi:[1,0,1]
    v_pk_fma_f32 v[242:243], v[98:99], v[116:117], v[242:243] op_sel_hi:[1,0,1]
    v_pk_fma_f32 v[244:245], v[100:101], v[116:117], v[244:245] op_sel_hi:[1,0,1]
    v_pk_fma_f32 v[246:247], v[102:103], v[116:117], v[246:247] op_sel_hi:[1,0,1]
    v_pk_mul_f32 v[88:89], v[240:241], v[240:241]
    v_pk_mul_f32 v[90:91], v[242:243], v[242:243]
    v_pk_mul_f32 v[92:93], v[244:245], v[244:245]
    v_pk_mul_f32 v[94:95], v[246:247], v[246:247]
    v_pk_fma_f32 v[88:89], v[88:89], v[118:119], v[116:117] op_sel:[0,0,1] op_sel_hi:[1,0,1]
    v_pk_fma_f32 v[90:91], v[90:91], v[118:119], v[116:117] op_sel:[0,0,1] op_sel_hi:[1,0,1]
    v_pk_fma_f32 v[92:93], v[92:93], v[118:119], v[116:117] op_sel:[0,0,1] op_sel_hi:[1,0,1]
    v_pk_fma_f32 v[94:95], v[94:95], v[118:119], v[116:117] op_sel:[0,0,1] op_sel_hi:[1,0,1]
    v_pk_mul_f32 v[88:89], v[88:89], v[240:241]
    v_pk_mul_f32 v[90:91], v[90:91], v[242:243]
    v_pk_mul_f32 v[92:93], v[92:93], v[244:245]
    v_pk_mul_f32 v[94:95], v[94:95], v[246:247]
    v_pk_fma_f32 v[248:249], v[104:105], v[116:117], v[248:249] op_sel_hi:[1,0,1]
    v_pk_fma_f32 v[250:251], v[106:107], v[116:117], v[250:251] op_sel_hi:[1,0,1]
    v_pk_fma_f32 v[252:253], v[108:109], v[116:117], v[252:253] op_sel_hi:[1,0,1]
    v_pk_fma_f32 v[254:255], v[110:111], v[116:117], v[254:255] op_sel_hi:[1,0,1]
    v_pk_mul_f32 v[248:249], v[248:249], v[240:241]
    v_pk_mul_f32 v[250:251], v[250:251], v[242:243]
    v_pk_mul_f32 v[252:253], v[252:253], v[244:245]
    v_pk_mul_f32 v[254:255], v[254:255], v[246:247]
    v_exp_f32 v88, v88
    v_exp_f32 v89, v89
    v_exp_f32 v90, v90
    v_exp_f32 v91, v91
    v_exp_f32 v92, v92
    v_exp_f32 v93, v93
    v_exp_f32 v94, v94
    v_exp_f32 v95, v95
    v_fma_f32 v88, v88, v119, v119
    v_fma_f32 v89, v89, v119, v119
    v_fma_f32 v90, v90, v119, v119
    v_fma_f32 v91, v91, v119, v119
    v_fma_f32 v92, v92, v119, v119
    v_fma_f32 v93, v93, v119, v119
    v_fma_f32 v94, v94, v119, v119
    v_fma_f32 v95, v95, v119, v119
    v_rcp_f32 v88, v88
    v_rcp_f32 v89, v89
    v_rcp_f32 v90, v90
    v_rcp_f32 v91, v91
    v_rcp_f32 v92, v92
    v_rcp_f32 v93, v93
    v_rcp_f32 v94, v94
    v_rcp_f32 v95, v95
    v_pk_mul_f32 v[248:249], v[248:249], v[88:89]
    v_pk_mul_f32 v[250:251], v[250:251], v[90:91]
    v_pk_mul_f32 v[252:253], v[252:253], v[92:93]
    v_pk_mul_f32 v[254:255], v[254:255], v[94:95]
    v_cvt_pk_bf16_f32 v240, v248, v249
    v_cvt_pk_bf16_f32 v241, v250, v251
    v_cvt_pk_bf16_f32 v242, v252, v253
    v_cvt_pk_bf16_f32 v243, v254, v255
    buffer_store_dwordx4 v[240:243], v6, s[16:19], s50 offen offset:1024 sc1
    s_branch L_cdone
L_cdft:
    s_lshl_b32 s50, s47, 12
    s_lshl_b32 s51, s49, 14
    s_sub_u32 s50, s50, s51
    s_add_u32 s50, s50, 32768
    v_add_u32 v12, s50, v8
    v_add_u32 v13, s50, v9
    s_lshl_b32 s51, s49, 9
    s_add_u32 s51, s51, 157696
    v_lshl_add_u32 v1, v3, 4, s51
    s_lshl_b32 s50, s47, 7
    s_add_u32 s50, s50, 161792
    v_lshl_add_u32 v7, v2, 2, s50
    v_mul_u32_u24 v6, 327680, v3
    v_lshl_add_u32 v6, v2, 4, v6
    s_lshl_b32 s50, s49, 3
    s_add_u32 s50, s50, s40
    s_mul_i32 s50, s50, 5120
    s_sub_u32 s51, s41, 27
    s_lshl_b32 s51, s51, 1
    s_add_u32 s51, s51, s47
    s_lshl_b32 s51, s51, 9
    s_add_u32 s50, s50, s51
    s_add_u32 s50, s50, 12582912
    v_lshlrev_b32 v104, 2, v3
    v_add_u32 v105, 0, v2
    v_add_u32 v106, 0, v104
    v_mul_u32_u24 v108, v106, v105
    v_add_u32 v109, v108, v105
    v_add_u32 v110, v109, v105
    v_add_u32 v111, v110, v105
    v_and_b32 v108, 31, v108
    v_and_b32 v109, 31, v109
    v_and_b32 v110, 31, v110
    v_and_b32 v111, 31, v111
    v_cvt_f32_u32 v108, v108
    v_cvt_f32_u32 v109, v109
    v_cvt_f32_u32 v110, v110
    v_cvt_f32_u32 v111, v111
    v_mul_f32 v108, 0x3d000000, v108
    v_mul_f32 v109, 0x3d000000, v109
    v_mul_f32 v110, 0x3d000000, v110
    v_mul_f32 v111, 0x3d000000, v111
    v_cos_f32 v112, v108
    v_cos_f32 v113, v109
    v_cos_f32 v114, v110
    v_cos_f32 v115, v111
    v_sin_f32 v108, v108
    v_sin_f32 v109, v109
    v_sin_f32 v110, v110
    v_sin_f32 v111, v111
    v_cvt_pk_bf16_f32 v80, v112, v113
    v_cvt_pk_bf16_f32 v81, v114, v115
    v_cvt_pk_bf16_f32 v88, v108, v109
    v_cvt_pk_bf16_f32 v89, v110, v111
    v_add_u32 v106, 16, v104
    v_mul_u32_u24 v108, v106, v105
    v_add_u32 v109, v108, v105
    v_add_u32 v110, v109, v105
    v_add_u32 v111, v110, v105
    v_and_b32 v108, 31, v108
    v_and_b32 v109, 31, v109
    v_and_b32 v110, 31, v110
    v_and_b32 v111, 31, v111
    v_cvt_f32_u32 v108, v108
    v_cvt_f32_u32 v109, v109
    v_cvt_f32_u32 v110, v110
    v_cvt_f32_u32 v111, v111
    v_mul_f32 v108, 0x3d000000, v108
    v_mul_f32 v109, 0x3d000000, v109
    v_mul_f32 v110, 0x3d000000, v110
    v_mul_f32 v111, 0x3d000000, v111
    v_cos_f32 v112, v108
    v_cos_f32 v113, v109
    v_cos_f32 v114, v110
    v_cos_f32 v115, v111
    v_sin_f32 v108, v108
    v_sin_f32 v109, v109
    v_sin_f32 v110, v110
    v_sin_f32 v111, v111
    v_cvt_pk_bf16_f32 v82, v112, v113
    v_cvt_pk_bf16_f32 v83, v114, v115
    v_cvt_pk_bf16_f32 v90, v108, v109
    v_cvt_pk_bf16_f32 v91, v110, v111
    v_add_u32 v105, 16, v2
    v_add_u32 v106, 0, v104
    v_mul_u32_u24 v108, v106, v105
    v_add_u32 v109, v108, v105
    v_add_u32 v110, v109, v105
    v_add_u32 v111, v110, v105
    v_and_b32 v108, 31, v108
    v_and_b32 v109, 31, v109
    v_and_b32 v110, 31, v110
    v_and_b32 v111, 31, v111
    v_cvt_f32_u32 v108, v108
    v_cvt_f32_u32 v109, v109
    v_cvt_f32_u32 v110, v110
    v_cvt_f32_u32 v111, v111
    v_mul_f32 v108, 0x3d000000, v108
    v_mul_f32 v109, 0x3d000000, v109
    v_mul_f32 v110, 0x3d000000, v110
    v_mul_f32 v111, 0x3d000000, v111
    v_cos_f32 v112, v108
    v_cos_f32 v113, v109
    v_cos_f32 v114, v110
    v_cos_f32 v115, v111
    v_sin_f32 v108, v108
    v_sin_f32 v109, v109
    v_sin_f32 v110, v110
    v_sin_f32 v111, v111
    v_cvt_pk_bf16_f32 v84, v112, v113
    v_cvt_pk_bf16_f32 v85, v114, v115
    v_cvt_pk_bf16_f32 v92, v108, v109
    v_cvt_pk_bf16_f32 v93, v110, v111
    v_add_u32 v106, 16, v104
    v_mul_u32_u24 v108, v106, v105
    v_add_u32 v109, v108, v105
    v_add_u32 v110, v109, v105
    v_add_u32 v111, v110, v105
    v_and_b32 v108, 31, v108
    v_and_b32 v109, 31, v109
    v_and_b32 v110, 31, v110
    v_and_b32 v111, 31, v111
    v_cvt_f32_u32 v108, v108
    v_cvt_f32_u32 v109, v109
    v_cvt_f32_u32 v110, v110
    v_cvt_f32_u32 v111, v111
    v_mul_f32 v108, 0x3d000000, v108
    v_mul_f32 v109, 0x3d000000, v109
    v_mul_f32 v110, 0x3d000000, v110
    v_mul_f32 v111, 0x3d000000, v111
    v_cos_f32 v112, v108
    v_cos_f32 v113, v109
    v_cos_f32 v114, v110
    v_cos_f32 v115, v111
    v_sin_f32 v108, v108
    v_sin_f32 v109, v109
    v_sin_f32 v110, v110
    v_sin_f32 v111, v111
    v_cvt_pk_bf16_f32 v86, v112, v113
    v_cvt_pk_bf16_f32 v87, v114, v115
    v_cvt_pk_bf16_f32 v94, v108, v109
    v_cvt_pk_bf16_f32 v95, v110, v111
    v_xor_b32 v96, 0x80008000, v80
    v_xor_b32 v97, 0x80008000, v81
    v_xor_b32 v98, 0x80008000, v82
    v_xor_b32 v99, 0x80008000, v83
    v_xor_b32 v100, 0x80008000, v84
    v_xor_b32 v101, 0x80008000, v85
    v_xor_b32 v102, 0x80008000, v86
    v_xor_b32 v103, 0x80008000, v87
    s_barrier
    ds_read_b128 v[16:19], v8 offset:0
    ds_read_b128 v[48:51], v12 offset:0
    ds_read_b128 v[20:23], v8 offset:2048
    ds_read_b128 v[52:55], v12 offset:2048
    ds_read_b128 v[24:27], v8 offset:4096
    ds_read_b128 v[56:59], v12 offset:8192
    ds_read_b128 v[28:31], v8 offset:6144
    ds_read_b128 v[60:63], v12 offset:10240
    ds_read_b128 v[32:35], v8 offset:8192
    ds_read_b128 v[36:39], v8 offset:10240
    ds_read_b128 v[40:43], v8 offset:12288
    ds_read_b128 v[44:47], v8 offset:14336
.p2align 3
L_cd_loop:
    s_waitcnt lgkmcnt(3)
    v_mfma_f32_16x16x32_bf16 v[128:131], v[16:19], v[48:51], v[128:131]
    ds_read_b128 v[64:67], v13 offset:0
    v_mfma_f32_16x16x32_bf16 v[132:135], v[16:19], v[52:55], v[132:135]
    v_mfma_f32_16x16x32_bf16 v[136:139], v[16:19], v[56:59], v[136:139]
    v_mfma_f32_16x16x32_bf16 v[140:143], v[16:19], v[60:63], v[140:143]
    ds_read_b128 v[16:19], v9 offset:0
    v_mfma_f32_16x16x32_bf16 v[144:147], v[20:23], v[48:51], v[144:147]
    ds_read_b128 v[68:71], v13 offset:2048
    v_mfma_f32_16x16x32_bf16 v[148:151], v[20:23], v[52:55], v[148:151]
    v_mfma_f32_16x16x32_bf16 v[152:155], v[20:23], v[56:59], v[152:155]
    v_mfma_f32_16x16x32_bf16 v[156:159], v[20:23], v[60:63], v[156:159]
    ds_read_b128 v[20:23], v9 offset:2048
    v_mfma_f32_16x16x32_bf16 v[160:163], v[24:27], v[48:51], v[160:163]
    ds_read_b128 v[72:75], v13 offset:8192
    v_mfma_f32_16x16x32_bf16 v[164:167], v[24:27], v[52:55], v[164:167]
    v_mfma_f32_16x16x32_bf16 v[168:171], v[24:27], v[56:59], v[168:171]
    v_mfma_f32_16x16x32_bf16 v[172:175], v[24:27], v[60:63], v[172:175]
    ds_read_b128 v[24:27], v9 offset:4096
    v_mfma_f32_16x16x32_bf16 v[176:179], v[28:31], v[48:51], v[176:179]
    ds_read_b128 v[76:79], v13 offset:10240
    v_mfma_f32_16x16x32_bf16 v[180:183], v[28:31], v[52:55], v[180:183]
    v_mfma_f32_16x16x32_bf16 v[184:187], v[28:31], v[56:59], v[184:187]
    v_mfma_f32_16x16x32_bf16 v[188:191], v[28:31], v[60:63], v[188:191]
    ds_read_b128 v[28:31], v9 offset:6144
    s_waitcnt lgkmcnt(8)
    v_mfma_f32_16x16x32_bf16 v[192:195], v[32:35], v[48:51], v[192:195]
    s_add_u32 s61, s61, 1
    v_mfma_f32_16x16x32_bf16 v[196:199], v[32:35], v[52:55], v[196:199]
    s_cmp_eq_u32 s61, 3
    v_mfma_f32_16x16x32_bf16 v[200:203], v[32:35], v[56:59], v[200:203]
    s_cselect_b32 s62, -147456, 0
    v_mfma_f32_16x16x32_bf16 v[204:207], v[32:35], v[60:63], v[204:207]
    ds_read_b128 v[32:35], v9 offset:8192
    v_mfma_f32_16x16x32_bf16 v[208:211], v[36:39], v[48:51], v[208:211]
    s_cselect_b32 s61, 0, s61
    v_mfma_f32_16x16x32_bf16 v[212:215], v[36:39], v[52:55], v[212:215]
    s_add_u32 s62, s62, 49152
    v_mfma_f32_16x16x32_bf16 v[216:219], v[36:39], v[56:59], v[216:219]
    v_add_u32 v8, s62, v8
    v_mfma_f32_16x16x32_bf16 v[220:223], v[36:39], v[60:63], v[220:223]
    ds_read_b128 v[36:39], v9 offset:10240
    v_mfma_f32_16x16x32_bf16 v[224:227], v[40:43], v[48:51], v[224:227]
    v_add_u32 v12, s62, v12
    v_mfma_f32_16x16x32_bf16 v[228:231], v[40:43], v[52:55], v[228:231]
    v_add_u32 v13, s62, v13
    v_mfma_f32_16x16x32_bf16 v[232:235], v[40:43], v[56:59], v[232:235]
    s_sub_u32 s60, s60, 1
    v_mfma_f32_16x16x32_bf16 v[236:239], v[40:43], v[60:63], v[236:239]
    ds_read_b128 v[40:43], v9 offset:12288
    v_mfma_f32_16x16x32_bf16 v[240:243], v[44:47], v[48:51], v[240:243]
    v_mfma_f32_16x16x32_bf16 v[244:247], v[44:47], v[52:55], v[244:247]
    v_mfma_f32_16x16x32_bf16 v[248:251], v[44:47], v[56:59], v[248:251]
    v_mfma_f32_16x16x32_bf16 v[252:255], v[44:47], v[60:63], v[252:255]
    ds_read_b128 v[44:47], v9 offset:14336
    ds_read_b32 v122, v120 offset:12
    s_waitcnt lgkmcnt(5)
    v_mfma_f32_16x16x32_bf16 v[128:131], v[16:19], v[64:67], v[128:131]
    v_add_u32 v9, s62, v9
    v_mfma_f32_16x16x32_bf16 v[132:135], v[16:19], v[68:71], v[132:135]
    s_cmp_le_u32 s60, 1
    v_mfma_f32_16x16x32_bf16 v[136:139], v[16:19], v[72:75], v[136:139]
    v_mfma_f32_16x16x32_bf16 v[140:143], v[16:19], v[76:79], v[140:143]
    s_cbranch_scc1 L_cd_rel
    s_waitcnt vmcnt(0) lgkmcnt(0)
    s_barrier
L_cd_reld:
    ds_read_b128 v[16:19], v8 offset:0
    v_mfma_f32_16x16x32_bf16 v[144:147], v[20:23], v[64:67], v[144:147]
    ds_read_b128 v[48:51], v12 offset:0
    v_mfma_f32_16x16x32_bf16 v[148:151], v[20:23], v[68:71], v[148:151]
    v_mfma_f32_16x16x32_bf16 v[152:155], v[20:23], v[72:75], v[152:155]
    v_mfma_f32_16x16x32_bf16 v[156:159], v[20:23], v[76:79], v[156:159]
    ds_read_b128 v[20:23], v8 offset:2048
    v_mfma_f32_16x16x32_bf16 v[160:163], v[24:27], v[64:67], v[160:163]
    ds_read_b128 v[52:55], v12 offset:2048
    v_mfma_f32_16x16x32_bf16 v[164:167], v[24:27], v[68:71], v[164:167]
    v_mfma_f32_16x16x32_bf16 v[168:171], v[24:27], v[72:75], v[168:171]
    v_mfma_f32_16x16x32_bf16 v[172:175], v[24:27], v[76:79], v[172:175]
    ds_read_b128 v[24:27], v8 offset:4096
    v_mfma_f32_16x16x32_bf16 v[176:179], v[28:31], v[64:67], v[176:179]
    ds_read_b128 v[56:59], v12 offset:8192
    v_mfma_f32_16x16x32_bf16 v[180:183], v[28:31], v[68:71], v[180:183]
    v_mfma_f32_16x16x32_bf16 v[184:187], v[28:31], v[72:75], v[184:187]
    v_mfma_f32_16x16x32_bf16 v[188:191], v[28:31], v[76:79], v[188:191]
    ds_read_b128 v[28:31], v8 offset:6144
    v_mfma_f32_16x16x32_bf16 v[192:195], v[32:35], v[64:67], v[192:195]
    ds_read_b128 v[60:63], v12 offset:10240
    v_mfma_f32_16x16x32_bf16 v[196:199], v[32:35], v[68:71], v[196:199]
    v_mfma_f32_16x16x32_bf16 v[200:203], v[32:35], v[72:75], v[200:203]
    v_mfma_f32_16x16x32_bf16 v[204:207], v[32:35], v[76:79], v[204:207]
    ds_read_b128 v[32:35], v8 offset:8192
    v_mfma_f32_16x16x32_bf16 v[208:211], v[36:39], v[64:67], v[208:211]
    v_mfma_f32_16x16x32_bf16 v[212:215], v[36:39], v[68:71], v[212:215]
    v_mfma_f32_16x16x32_bf16 v[216:219], v[36:39], v[72:75], v[216:219]
    v_mfma_f32_16x16x32_bf16 v[220:223], v[36:39], v[76:79], v[220:223]
    ds_read_b128 v[36:39], v8 offset:10240
    v_mfma_f32_16x16x32_bf16 v[224:227], v[40:43], v[64:67], v[224:227]
    v_mfma_f32_16x16x32_bf16 v[228:231], v[40:43], v[68:71], v[228:231]
    v_mfma_f32_16x16x32_bf16 v[232:235], v[40:43], v[72:75], v[232:235]
    v_mfma_f32_16x16x32_bf16 v[236:239], v[40:43], v[76:79], v[236:239]
    ds_read_b128 v[40:43], v8 offset:12288
    v_mfma_f32_16x16x32_bf16 v[240:243], v[44:47], v[64:67], v[240:243]
    v_mfma_f32_16x16x32_bf16 v[244:247], v[44:47], v[68:71], v[244:247]
    v_mfma_f32_16x16x32_bf16 v[248:251], v[44:47], v[72:75], v[248:251]
    s_cmp_lg_u32 s60, 0
    v_mfma_f32_16x16x32_bf16 v[252:255], v[44:47], v[76:79], v[252:255]
    ds_read_b128 v[44:47], v8 offset:14336
    s_cbranch_scc1 L_cd_loop
    s_branch L_cd_epi
L_cd_rel:
    s_mov_b32 s62, 0
    s_waitcnt lgkmcnt(0)
    s_mov_b64 exec, 1
    ds_add_u32 v120, v121 offset:4
    s_mov_b64 exec, -1
L_cd_land:
    v_cmp_gt_u32 vcc, 3, v122
    s_cbranch_vccz L_cd_reld
    ds_read_b32 v122, v120 offset:12
    s_add_u32 s62, s62, 1
    s_waitcnt lgkmcnt(0)
    s_cmp_lt_u32 s62, 0x400000
    s_cbranch_scc1 L_cd_land
    s_branch L_cd_reld
L_cd_epi:
    s_setprio 3
    s_mov_b32 s60, 0
L_cd_rdy:
    ds_read_b32 v122, v120 offset:8
    ds_read_b32 v123, v120 offset:20
    ds_read_b32 v8, v7 offset:0
    ds_read_b32 v9, v7 offset:64
    ds_read_b32 v10, v7 offset:256
    ds_read_b32 v11, v7 offset:320
    ds_read_b128 v[16:19], v1 offset:0
    ds_read_b128 v[48:51], v1 offset:1024
    ds_read_b128 v[20:23], v1 offset:64
    ds_read_b128 v[52:55], v1 offset:1088
    ds_read_b128 v[24:27], v1 offset:128
    ds_read_b128 v[56:59], v1 offset:1152
    ds_read_b128 v[28:31], v1 offset:192
    ds_read_b128 v[60:63], v1 offset:1216
    s_waitcnt lgkmcnt(0)
    v_cmp_eq_u32 vcc, 0, v122
    s_add_u32 s60, s60, 1
    s_cbranch_vccz L_cd_go
    s_cmp_lt_u32 s60, 0x400000
    s_cbranch_scc1 L_cd_rdy
L_cd_go:
    ds_read_b128 v[32:35], v1 offset:256
    ds_read_b128 v[64:67], v1 offset:1280
    ds_read_b128 v[36:39], v1 offset:320
    ds_read_b128 v[68:71], v1 offset:1344
    ds_read_b128 v[40:43], v1 offset:384
    ds_read_b128 v[72:75], v1 offset:1408
    ds_read_b128 v[44:47], v1 offset:448
    ds_read_b128 v[76:79], v1 offset:1472
    v_pk_mul_f32 v[104:105], v[48:49], v[8:9] op_sel_hi:[1,0]
    v_pk_mul_f32 v[106:107], v[50:51], v[8:9] op_sel_hi:[1,0]
    v_pk_mul_f32 v[108:109], v[52:53], v[8:9] op_sel_hi:[1,0]
    v_pk_mul_f32 v[110:111], v[54:55], v[8:9] op_sel_hi:[1,0]
    v_pk_fma_f32 v[104:105], v[128:129], v[16:17], v[104:105]
    v_pk_fma_f32 v[106:107], v[130:131], v[18:19], v[106:107]
    v_pk_fma_f32 v[108:109], v[144:145], v[20:21], v[108:109]
    v_pk_fma_f32 v[110:111], v[146:147], v[22:23], v[110:111]
    v_cvt_pk_bf16_f32 v128, v104, v105
    v_cvt_pk_bf16_f32 v129, v106, v107
    v_cvt_pk_bf16_f32 v130, v108, v109
    v_cvt_pk_bf16_f32 v131, v110, v111
    v_pk_mul_f32 v[104:105], v[48:49], v[10:11] op_sel_hi:[1,0]
    v_pk_mul_f32 v[106:107], v[50:51], v[10:11] op_sel_hi:[1,0]
    v_pk_mul_f32 v[108:109], v[52:53], v[10:11] op_sel_hi:[1,0]
    v_pk_mul_f32 v[110:111], v[54:55], v[10:11] op_sel_hi:[1,0]
    v_pk_fma_f32 v[104:105], v[136:137], v[16:17], v[104:105]
    v_pk_fma_f32 v[106:107], v[138:139], v[18:19], v[106:107]
    v_pk_fma_f32 v[108:109], v[152:153], v[20:21], v[108:109]
    v_pk_fma_f32 v[110:111], v[154:155], v[22:23], v[110:111]
    v_cvt_pk_bf16_f32 v136, v104, v105
    v_cvt_pk_bf16_f32 v137, v106, v107
    v_cvt_pk_bf16_f32 v138, v108, v109
    v_cvt_pk_bf16_f32 v139, v110, v111
    v_pk_mul_f32 v[104:105], v[56:57], v[8:9] op_sel_hi:[1,0]
    v_pk_mul_f32 v[106:107], v[58:59], v[8:9] op_sel_hi:[1,0]
    v_pk_mul_f32 v[108:109], v[60:61], v[8:9] op_sel_hi:[1,0]
    v_pk_mul_f32 v[110:111], v[62:63], v[8:9] op_sel_hi:[1,0]
    v_pk_fma_f32 v[104:105], v[160:161], v[24:25], v[104:105]
    v_pk_fma_f32 v[106:107], v[162:163], v[26:27], v[106:107]
    v_pk_fma_f32 v[108:109], v[176:177], v[28:29], v[108:109]
    v_pk_fma_f32 v[110:111], v[178:179], v[30:31], v[110:111]
    v_cvt_pk_bf16_f32 v160, v104, v105
    v_cvt_pk_bf16_f32 v161, v106, v107
    v_cvt_pk_bf16_f32 v162, v108, v109
    v_cvt_pk_bf16_f32 v163, v110, v111
    v_pk_mul_f32 v[104:105], v[56:57], v[10:11] op_sel_hi:[1,0]
    v_pk_mul_f32 v[106:107], v[58:59], v[10:11] op_sel_hi:[1,0]
    v_pk_mul_f32 v[108:109], v[60:61], v[10:11] op_sel_hi:[1,0]
    v_pk_mul_f32 v[110:111], v[62:63], v[10:11] op_sel_hi:[1,0]
    v_pk_fma_f32 v[104:105], v[168:169], v[24:25], v[104:105]
    v_pk_fma_f32 v[106:107], v[170:171], v[26:27], v[106:107]
    v_pk_fma_f32 v[108:109], v[184:185], v[28:29], v[108:109]
    v_pk_fma_f32 v[110:111], v[186:187], v[30:31], v[110:111]
    v_cvt_pk_bf16_f32 v168, v104, v105
    v_cvt_pk_bf16_f32 v169, v106, v107
    v_cvt_pk_bf16_f32 v170, v108, v109
    v_cvt_pk_bf16_f32 v171, v110, v111
    s_waitcnt lgkmcnt(0)
    v_pk_mul_f32 v[104:105], v[64:65], v[8:9] op_sel_hi:[1,0]
    v_pk_mul_f32 v[106:107], v[66:67], v[8:9] op_sel_hi:[1,0]
    v_pk_mul_f32 v[108:109], v[68:69], v[8:9] op_sel_hi:[1,0]
    v_pk_mul_f32 v[110:111], v[70:71], v[8:9] op_sel_hi:[1,0]
    v_pk_fma_f32 v[104:105], v[192:193], v[32:33], v[104:105]
    v_pk_fma_f32 v[106:107], v[194:195], v[34:35], v[106:107]
    v_pk_fma_f32 v[108:109], v[208:209], v[36:37], v[108:109]
    v_pk_fma_f32 v[110:111], v[210:211], v[38:39], v[110:111]
    v_cvt_pk_bf16_f32 v192, v104, v105
    v_cvt_pk_bf16_f32 v193, v106, v107
    v_cvt_pk_bf16_f32 v194, v108, v109
    v_cvt_pk_bf16_f32 v195, v110, v111
    v_pk_mul_f32 v[104:105], v[64:65], v[10:11] op_sel_hi:[1,0]
    v_pk_mul_f32 v[106:107], v[66:67], v[10:11] op_sel_hi:[1,0]
    v_pk_mul_f32 v[108:109], v[68:69], v[10:11] op_sel_hi:[1,0]
    v_pk_mul_f32 v[110:111], v[70:71], v[10:11] op_sel_hi:[1,0]
    v_pk_fma_f32 v[104:105], v[200:201], v[32:33], v[104:105]
    v_pk_fma_f32 v[106:107], v[202:203], v[34:35], v[106:107]
    v_pk_fma_f32 v[108:109], v[216:217], v[36:37], v[108:109]
    v_pk_fma_f32 v[110:111], v[218:219], v[38:39], v[110:111]
    v_cvt_pk_bf16_f32 v200, v104, v105
    v_cvt_pk_bf16_f32 v201, v106, v107
    v_cvt_pk_bf16_f32 v202, v108, v109
    v_cvt_pk_bf16_f32 v203, v110, v111
    v_pk_mul_f32 v[104:105], v[72:73], v[8:9] op_sel_hi:[1,0]
    v_pk_mul_f32 v[106:107], v[74:75], v[8:9] op_sel_hi:[1,0]
    v_pk_mul_f32 v[108:109], v[76:77], v[8:9] op_sel_hi:[1,0]
    v_pk_mul_f32 v[110:111], v[78:79], v[8:9] op_sel_hi:[1,0]
    v_pk_fma_f32 v[104:105], v[224:225], v[40:41], v[104:105]
    v_pk_fma_f32 v[106:107], v[226:227], v[42:43], v[106:107]
    v_pk_fma_f32 v[108:109], v[240:241], v[44:45], v[108:109]
    v_pk_fma_f32 v[110:111], v[242:243], v[46:47], v[110:111]
    v_cvt_pk_bf16_f32 v224, v104, v105
    v_cvt_pk_bf16_f32 v225, v106, v107
    v_cvt_pk_bf16_f32 v226, v108, v109
    v_cvt_pk_bf16_f32 v227, v110, v111
    v_pk_mul_f32 v[104:105], v[72:73], v[10:11] op_sel_hi:[1,0]
    v_pk_mul_f32 v[106:107], v[74:75], v[10:11] op_sel_hi:[1,0]
    v_pk_mul_f32 v[108:109], v[76:77], v[10:11] op_sel_hi:[1,0]
    v_pk_mul_f32 v[110:111], v[78:79], v[10:11] op_sel_hi:[1,0]
    v_pk_fma_f32 v[104:105], v[232:233], v[40:41], v[104:105]
    v_pk_fma_f32 v[106:107], v[234:235], v[42:43], v[106:107]
    v_pk_fma_f32 v[108:109], v[248:249], v[44:45], v[108:109]
    v_pk_fma_f32 v[110:111], v[250:251], v[46:47], v[110:111]
    v_cvt_pk_bf16_f32 v232, v104, v105
    v_cvt_pk_bf16_f32 v233, v106, v107
    v_cvt_pk_bf16_f32 v234, v108, v109
    v_cvt_pk_bf16_f32 v235, v110, v111
    v_pk_mul_f32 v[104:105], v[48:49], v[8:9] op_sel:[0,1] op_sel_hi:[1,1]
    v_pk_mul_f32 v[106:107], v[50:51], v[8:9] op_sel:[0,1] op_sel_hi:[1,1]
    v_pk_mul_f32 v[108:109], v[52:53], v[8:9] op_sel:[0,1] op_sel_hi:[1,1]
    v_pk_mul_f32 v[110:111], v[54:55], v[8:9] op_sel:[0,1] op_sel_hi:[1,1]
    v_pk_fma_f32 v[104:105], v[132:133], v[16:17], v[104:105]
    v_pk_fma_f32 v[106:107], v[134:135], v[18:19], v[106:107]
    v_pk_fma_f32 v[108:109], v[148:149], v[20:21], v[108:109]
    v_pk_fma_f32 v[110:111], v[150:151], v[22:23], v[110:111]
    v_cvt_pk_bf16_f32 v132, v104, v105
    v_cvt_pk_bf16_f32 v133, v106, v107
    v_cvt_pk_bf16_f32 v134, v108, v109
    v_cvt_pk_bf16_f32 v135, v110, v111
    v_pk_mul_f32 v[104:105], v[48:49], v[10:11] op_sel:[0,1] op_sel_hi:[1,1]
    v_pk_mul_f32 v[106:107], v[50:51], v[10:11] op_sel:[0,1] op_sel_hi:[1,1]
    v_pk_mul_f32 v[108:109], v[52:53], v[10:11] op_sel:[0,1] op_sel_hi:[1,1]
    v_pk_mul_f32 v[110:111], v[54:55], v[10:11] op_sel:[0,1] op_sel_hi:[1,1]
    v_pk_fma_f32 v[104:105], v[140:141], v[16:17], v[104:105]
    v_pk_fma_f32 v[106:107], v[142:143], v[18:19], v[106:107]
    v_pk_fma_f32 v[108:109], v[156:157], v[20:21], v[108:109]
    v_pk_fma_f32 v[110:111], v[158:159], v[22:23], v[110:111]
    v_cvt_pk_bf16_f32 v140, v104, v105
    v_cvt_pk_bf16_f32 v141, v106, v107
    v_cvt_pk_bf16_f32 v142, v108, v109
    v_cvt_pk_bf16_f32 v143, v110, v111
    v_pk_mul_f32 v[104:105], v[56:57], v[8:9] op_sel:[0,1] op_sel_hi:[1,1]
    v_pk_mul_f32 v[106:107], v[58:59], v[8:9] op_sel:[0,1] op_sel_hi:[1,1]
    v_pk_mul_f32 v[108:109], v[60:61], v[8:9] op_sel:[0,1] op_sel_hi:[1,1]
    v_pk_mul_f32 v[110:111], v[62:63], v[8:9] op_sel:[0,1] op_sel_hi:[1,1]
    v_pk_fma_f32 v[104:105], v[164:165], v[24:25], v[104:105]
    v_pk_fma_f32 v[106:107], v[166:167], v[26:27], v[106:107]
    v_pk_fma_f32 v[108:109], v[180:181], v[28:29], v[108:109]
    v_pk_fma_f32 v[110:111], v[182:183], v[30:31], v[110:111]
    v_cvt_pk_bf16_f32 v164, v104, v105
    v_cvt_pk_bf16_f32 v165, v106, v107
    v_cvt_pk_bf16_f32 v166, v108, v109
    v_cvt_pk_bf16_f32 v167, v110, v111
    v_pk_mul_f32 v[104:105], v[56:57], v[10:11] op_sel:[0,1] op_sel_hi:[1,1]
    v_pk_mul_f32 v[106:107], v[58:59], v[10:11] op_sel:[0,1] op_sel_hi:[1,1]
    v_pk_mul_f32 v[108:109], v[60:61], v[10:11] op_sel:[0,1] op_sel_hi:[1,1]
    v_pk_mul_f32 v[110:111], v[62:63], v[10:11] op_sel:[0,1] op_sel_hi:[1,1]
    v_pk_fma_f32 v[104:105], v[172:173], v[24:25], v[104:105]
    v_pk_fma_f32 v[106:107], v[174:175], v[26:27], v[106:107]
    v_pk_fma_f32 v[108:109], v[188:189], v[28:29], v[108:109]
    v_pk_fma_f32 v[110:111], v[190:191], v[30:31], v[110:111]
    v_cvt_pk_bf16_f32 v172, v104, v105
    v_cvt_pk_bf16_f32 v173, v106, v107
    v_cvt_pk_bf16_f32 v174, v108, v109
    v_cvt_pk_bf16_f32 v175, v110, v111
    v_pk_mul_f32 v[104:105], v[64:65], v[8:9] op_sel:[0,1] op_sel_hi:[1,1]
    v_pk_mul_f32 v[106:107], v[66:67], v[8:9] op_sel:[0,1] op_sel_hi:[1,1]
    v_pk_mul_f32 v[108:109], v[68:69], v[8:9] op_sel:[0,1] op_sel_hi:[1,1]
    v_pk_mul_f32 v[110:111], v[70:71], v[8:9] op_sel:[0,1] op_sel_hi:[1,1]
    v_pk_fma_f32 v[104:105], v[196:197], v[32:33], v[104:105]
    v_pk_fma_f32 v[106:107], v[198:199], v[34:35], v[106:107]
    v_pk_fma_f32 v[108:109], v[212:213], v[36:37], v[108:109]
    v_pk_fma_f32 v[110:111], v[214:215], v[38:39], v[110:111]
    v_cvt_pk_bf16_f32 v196, v104, v105
    v_cvt_pk_bf16_f32 v197, v106, v107
    v_cvt_pk_bf16_f32 v198, v108, v109
    v_cvt_pk_bf16_f32 v199, v110, v111
    v_pk_mul_f32 v[104:105], v[64:65], v[10:11] op_sel:[0,1] op_sel_hi:[1,1]
    v_pk_mul_f32 v[106:107], v[66:67], v[10:11] op_sel:[0,1] op_sel_hi:[1,1]
    v_pk_mul_f32 v[108:109], v[68:69], v[10:11] op_sel:[0,1] op_sel_hi:[1,1]
    v_pk_mul_f32 v[110:111], v[70:71], v[10:11] op_sel:[0,1] op_sel_hi:[1,1]
    v_pk_fma_f32 v[104:105], v[204:205], v[32:33], v[104:105]
    v_pk_fma_f32 v[106:107], v[206:207], v[34:35], v[106:107]
    v_pk_fma_f32 v[108:109], v[220:221], v[36:37], v[108:109]
    v_pk_fma_f32 v[110:111], v[222:223], v[38:39], v[110:111]
    v_cvt_pk_bf16_f32 v204, v104, v105
    v_cvt_pk_bf16_f32 v205, v106, v107
    v_cvt_pk_bf16_f32 v206, v108, v109
    v_cvt_pk_bf16_f32 v207, v110, v111
    v_pk_mul_f32 v[104:105], v[72:73], v[8:9] op_sel:[0,1] op_sel_hi:[1,1]
    v_pk_mul_f32 v[106:107], v[74:75], v[8:9] op_sel:[0,1] op_sel_hi:[1,1]
    v_pk_mul_f32 v[108:109], v[76:77], v[8:9] op_sel:[0,1] op_sel_hi:[1,1]
    v_pk_mul_f32 v[110:111], v[78:79], v[8:9] op_sel:[0,1] op_sel_hi:[1,1]
    v_pk_fma_f32 v[104:105], v[228:229], v[40:41], v[104:105]
    v_pk_fma_f32 v[106:107], v[230:231], v[42:43], v[106:107]
    v_pk_fma_f32 v[108:109], v[244:245], v[44:45], v[108:109]
    v_pk_fma_f32 v[110:111], v[246:247], v[46:47], v[110:111]
    v_cvt_pk_bf16_f32 v228, v104, v105
    v_cvt_pk_bf16_f32 v229, v106, v107
    v_cvt_pk_bf16_f32 v230, v108, v109
    v_cvt_pk_bf16_f32 v231, v110, v111
    v_pk_mul_f32 v[104:105], v[72:73], v[10:11] op_sel:[0,1] op_sel_hi:[1,1]
    v_pk_mul_f32 v[106:107], v[74:75], v[10:11] op_sel:[0,1] op_sel_hi:[1,1]
    v_pk_mul_f32 v[108:109], v[76:77], v[10:11] op_sel:[0,1] op_sel_hi:[1,1]
    v_pk_mul_f32 v[110:111], v[78:79], v[10:11] op_sel:[0,1] op_sel_hi:[1,1]
    v_pk_fma_f32 v[104:105], v[236:237], v[40:41], v[104:105]
    v_pk_fma_f32 v[106:107], v[238:239], v[42:43], v[106:107]
    v_pk_fma_f32 v[108:109], v[252:253], v[44:45], v[108:109]
    v_pk_fma_f32 v[110:111], v[254:255], v[46:47], v[110:111]
    v_cvt_pk_bf16_f32 v236, v104, v105
    v_cvt_pk_bf16_f32 v237, v106, v107
    v_cvt_pk_bf16_f32 v238, v108, v109
    v_cvt_pk_bf16_f32 v239, v110, v111
    s_nop 1
    v_mfma_f32_16x16x32_bf16 v[144:147], v[80:83], v[128:131], 0
    v_mfma_f32_16x16x32_bf16 v[152:155], v[88:91], v[128:131], 0
    v_mfma_f32_16x16x32_bf16 v[176:179], v[80:83], v[160:163], 0
    v_mfma_f32_16x16x32_bf16 v[184:187], v[88:91], v[160:163], 0
    v_mfma_f32_16x16x32_bf16 v[208:211], v[80:83], v[192:195], 0
    v_mfma_f32_16x16x32_bf16 v[216:219], v[88:91], v[192:195], 0
    v_mfma_f32_16x16x32_bf16 v[240:243], v[80:83], v[224:227], 0
    v_mfma_f32_16x16x32_bf16 v[248:251], v[88:91], v[224:227], 0
    v_mfma_f32_16x16x32_bf16 v[144:147], v[88:91], v[136:139], v[144:147]
    v_mfma_f32_16x16x32_bf16 v[152:155], v[96:99], v[136:139], v[152:155]
    v_mfma_f32_16x16x32_bf16 v[176:179], v[88:91], v[168:171], v[176:179]
    v_mfma_f32_16x16x32_bf16 v[184:187], v[96:99], v[168:171], v[184:187]
    v_mfma_f32_16x16x32_bf16 v[208:211], v[88:91], v[200:203], v[208:211]
    v_mfma_f32_16x16x32_bf16 v[216:219], v[96:99], v[200:203], v[216:219]
    v_mfma_f32_16x16x32_bf16 v[240:243], v[88:91], v[232:235], v[240:243]
    v_mfma_f32_16x16x32_bf16 v[248:251], v[96:99], v[232:235], v[248:251]
    v_mfma_f32_16x16x32_bf16 v[148:151], v[84:87], v[128:131], 0
    v_mfma_f32_16x16x32_bf16 v[156:159], v[92:95], v[128:131], 0
    v_mfma_f32_16x16x32_bf16 v[180:183], v[84:87], v[160:163], 0
    v_mfma_f32_16x16x32_bf16 v[188:191], v[92:95], v[160:163], 0
    v_mfma_f32_16x16x32_bf16 v[212:215], v[84:87], v[192:195], 0
    v_mfma_f32_16x16x32_bf16 v[220:223], v[92:95], v[192:195], 0
    v_mfma_f32_16x16x32_bf16 v[244:247], v[84:87], v[224:227], 0
    v_mfma_f32_16x16x32_bf16 v[252:255], v[92:95], v[224:227], 0
    v_mfma_f32_16x16x32_bf16 v[148:151], v[92:95], v[136:139], v[148:151]
    v_cvt_pk_bf16_f32 v104, v144, v176
    v_cvt_pk_bf16_f32 v105, v208, v240
    v_cvt_pk_bf16_f32 v106, v152, v184
    v_mfma_f32_16x16x32_bf16 v[156:159], v[100:103], v[136:139], v[156:159]
    v_cvt_pk_bf16_f32 v107, v216, v248
    s_add_u32 s51, s50, 0
    buffer_store_dwordx4 v[104:107], v6, s[16:19], s51 offen sc1
    v_cvt_pk_bf16_f32 v108, v145, v177
    v_mfma_f32_16x16x32_bf16 v[180:183], v[92:95], v[168:171], v[180:183]
    v_cvt_pk_bf16_f32 v109, v209, v241
    v_cvt_pk_bf16_f32 v110, v153, v185
    v_cvt_pk_bf16_f32 v111, v217, v249
    v_mfma_f32_16x16x32_bf16 v[188:191], v[100:103], v[168:171], v[188:191]
    s_add_u32 s51, s50, 81920
    buffer_store_dwordx4 v[108:111], v6, s[16:19], s51 offen sc1
    v_cvt_pk_bf16_f32 v104, v146, v178
    v_cvt_pk_bf16_f32 v105, v210, v242
    v_mfma_f32_16x16x32_bf16 v[212:215], v[92:95], v[200:203], v[212:215]
    v_cvt_pk_bf16_f32 v106, v154, v186
    v_cvt_pk_bf16_f32 v107, v218, v250
    s_add_u32 s51, s50, 163840
    buffer_store_dwordx4 v[104:107], v6, s[16:19], s51 offen sc1
    v_mfma_f32_16x16x32_bf16 v[220:223], v[100:103], v[200:203], v[220:223]
    v_cvt_pk_bf16_f32 v108, v147, v179
    v_cvt_pk_bf16_f32 v109, v211, v243
    v_cvt_pk_bf16_f32 v110, v155, v187
    v_mfma_f32_16x16x32_bf16 v[244:247], v[92:95], v[232:235], v[244:247]
    v_cvt_pk_bf16_f32 v111, v219, v251
    s_add_u32 s51, s50, 245760
    buffer_store_dwordx4 v[108:111], v6, s[16:19], s51 offen sc1
    v_mfma_f32_16x16x32_bf16 v[252:255], v[100:103], v[232:235], v[252:255]
    v_mfma_f32_16x16x32_bf16 v[144:147], v[80:83], v[132:135], 0
    v_mfma_f32_16x16x32_bf16 v[152:155], v[88:91], v[132:135], 0
    v_mfma_f32_16x16x32_bf16 v[176:179], v[80:83], v[164:167], 0
    v_mfma_f32_16x16x32_bf16 v[184:187], v[88:91], v[164:167], 0
    v_mfma_f32_16x16x32_bf16 v[208:211], v[80:83], v[196:199], 0
    v_mfma_f32_16x16x32_bf16 v[216:219], v[88:91], v[196:199], 0
    v_mfma_f32_16x16x32_bf16 v[240:243], v[80:83], v[228:231], 0
    v_mfma_f32_16x16x32_bf16 v[248:251], v[88:91], v[228:231], 0
    v_mfma_f32_16x16x32_bf16 v[144:147], v[88:91], v[140:143], v[144:147]
    v_cvt_pk_bf16_f32 v104, v148, v180
    v_cvt_pk_bf16_f32 v105, v212, v244
    v_cvt_pk_bf16_f32 v106, v156, v188
    v_mfma_f32_16x16x32_bf16 v[152:155], v[96:99], v[140:143], v[152:155]
    v_cvt_pk_bf16_f32 v107, v220, v252
    s_add_u32 s51, s50, 1310720
    buffer_store_dwordx4 v[104:107], v6, s[16:19], s51 offen sc1
    v_cvt_pk_bf16_f32 v108, v149, v181
    v_mfma_f32_16x16x32_bf16 v[176:179], v[88:91], v[172:175], v[176:179]
    v_cvt_pk_bf16_f32 v109, v213, v245
    v_cvt_pk_bf16_f32 v110, v157, v189
    v_cvt_pk_bf16_f32 v111, v221, v253
    v_mfma_f32_16x16x32_bf16 v[184:187], v[96:99], v[172:175], v[184:187]
    s_add_u32 s51, s50, 1392640
    buffer_store_dwordx4 v[108:111], v6, s[16:19], s51 offen sc1
    v_cvt_pk_bf16_f32 v104, v150, v182
    v_cvt_pk_bf16_f32 v105, v214, v246
    v_mfma_f32_16x16x32_bf16 v[208:211], v[88:91], v[204:207], v[208:211]
    v_cvt_pk_bf16_f32 v106, v158, v190
    v_cvt_pk_bf16_f32 v107, v222, v254
    s_add_u32 s51, s50, 1474560
    buffer_store_dwordx4 v[104:107], v6, s[16:19], s51 offen sc1
    v_mfma_f32_16x16x32_bf16 v[216:219], v[96:99], v[204:207], v[216:219]
    v_cvt_pk_bf16_f32 v108, v151, v183
    v_cvt_pk_bf16_f32 v109, v215, v247
    v_cvt_pk_bf16_f32 v110, v159, v191
    v_mfma_f32_16x16x32_bf16 v[240:243], v[88:91], v[236:239], v[240:243]
    v_cvt_pk_bf16_f32 v111, v223, v255
    s_add_u32 s51, s50, 1556480
    buffer_store_dwordx4 v[108:111], v6, s[16:19], s51 offen sc1
    v_mfma_f32_16x16x32_bf16 v[248:251], v[96:99], v[236:239], v[248:251]
    v_mfma_f32_16x16x32_bf16 v[148:151], v[84:87], v[132:135], 0
    v_mfma_f32_16x16x32_bf16 v[156:159], v[92:95], v[132:135], 0
    v_mfma_f32_16x16x32_bf16 v[180:183], v[84:87], v[164:167], 0
    v_mfma_f32_16x16x32_bf16 v[188:191], v[92:95], v[164:167], 0
    v_mfma_f32_16x16x32_bf16 v[212:215], v[84:87], v[196:199], 0
    v_mfma_f32_16x16x32_bf16 v[220:223], v[92:95], v[196:199], 0
    v_mfma_f32_16x16x32_bf16 v[244:247], v[84:87], v[228:231], 0
    v_mfma_f32_16x16x32_bf16 v[252:255], v[92:95], v[228:231], 0
    v_mfma_f32_16x16x32_bf16 v[148:151], v[92:95], v[140:143], v[148:151]
    v_cvt_pk_bf16_f32 v104, v144, v176
    v_cvt_pk_bf16_f32 v105, v208, v240
    v_cvt_pk_bf16_f32 v106, v152, v184
    v_mfma_f32_16x16x32_bf16 v[156:159], v[100:103], v[140:143], v[156:159]
    v_cvt_pk_bf16_f32 v107, v216, v248
    s_add_u32 s51, s50, 256
    buffer_store_dwordx4 v[104:107], v6, s[16:19], s51 offen sc1
    v_cvt_pk_bf16_f32 v108, v145, v177
    v_mfma_f32_16x16x32_bf16 v[180:183], v[92:95], v[172:175], v[180:183]
    v_cvt_pk_bf16_f32 v109, v209, v241
    v_cvt_pk_bf16_f32 v110, v153, v185
    v_cvt_pk_bf16_f32 v111, v217, v249
    v_mfma_f32_16x16x32_bf16 v[188:191], v[100:103], v[172:175], v[188:191]
    s_add_u32 s51, s50, 82176
    buffer_store_dwordx4 v[108:111], v6, s[16:19], s51 offen sc1
    v_cvt_pk_bf16_f32 v104, v146, v178
    v_cvt_pk_bf16_f32 v105, v210, v242
    v_mfma_f32_16x16x32_bf16 v[212:215], v[92:95], v[204:207], v[212:215]
    v_cvt_pk_bf16_f32 v106, v154, v186
    v_cvt_pk_bf16_f32 v107, v218, v250
    s_add_u32 s51, s50, 164096
    buffer_store_dwordx4 v[104:107], v6, s[16:19], s51 offen sc1
    v_mfma_f32_16x16x32_bf16 v[220:223], v[100:103], v[204:207], v[220:223]
    v_cvt_pk_bf16_f32 v108, v147, v179
    v_cvt_pk_bf16_f32 v109, v211, v243
    v_cvt_pk_bf16_f32 v110, v155, v187
    v_mfma_f32_16x16x32_bf16 v[244:247], v[92:95], v[236:239], v[244:247]
    v_cvt_pk_bf16_f32 v111, v219, v251
    s_add_u32 s51, s50, 246016
    buffer_store_dwordx4 v[108:111], v6, s[16:19], s51 offen sc1
    v_mfma_f32_16x16x32_bf16 v[252:255], v[100:103], v[236:239], v[252:255]
    s_nop 7
    v_cvt_pk_bf16_f32 v104, v148, v180
    v_cvt_pk_bf16_f32 v105, v212, v244
    v_cvt_pk_bf16_f32 v106, v156, v188
    v_cvt_pk_bf16_f32 v107, v220, v252
    s_add_u32 s51, s50, 1310976
    buffer_store_dwordx4 v[104:107], v6, s[16:19], s51 offen sc1
    v_cvt_pk_bf16_f32 v108, v149, v181
    v_cvt_pk_bf16_f32 v109, v213, v245
    v_cvt_pk_bf16_f32 v110, v157, v189
    v_cvt_pk_bf16_f32 v111, v221, v253
    s_add_u32 s51, s50, 1392896
    buffer_store_dwordx4 v[108:111], v6, s[16:19], s51 offen sc1
    v_cvt_pk_bf16_f32 v104, v150, v182
    v_cvt_pk_bf16_f32 v105, v214, v246
    v_cvt_pk_bf16_f32 v106, v158, v190
    v_cvt_pk_bf16_f32 v107, v222, v254
    s_add_u32 s51, s50, 1474816
    buffer_store_dwordx4 v[104:107], v6, s[16:19], s51 offen sc1
    v_cvt_pk_bf16_f32 v108, v151, v183
    v_cvt_pk_bf16_f32 v109, v215, v247
    v_cvt_pk_bf16_f32 v110, v159, v191
    v_cvt_pk_bf16_f32 v111, v223, v255
    s_add_u32 s51, s50, 1556736
    buffer_store_dwordx4 v[108:111], v6, s[16:19], s51 offen sc1
L_cdone:
    s_lshl_b32 s46, s40, 5
    s_add_u32 s46, s46, s41
    s_lshl_b32 s46, s46, 7
    s_add_u32 s46, s46, 32768
    v_mov_b32 v124, 0
    s_waitcnt vmcnt(0)
    s_mov_b64 exec, 1
    ds_add_rtn_u32 v122, v120, v121
    s_waitcnt lgkmcnt(0)
    v_cmp_eq_u32 vcc, 3, v122
    s_cbranch_vccz L_nofl
    buffer_store_dword v123, v124, s[16:19], s46 offen sc1
L_nofl:
    s_mov_b64 exec, -1
    s_setprio 0
    s_mov_b32 s50, 3277
    s_lshl_b32 s51, s42, 7
    v_add_u32 v8, s51, v0
    v_mul_u32_u24 v9, s50, v8
    v_lshrrev_b32 v9, 16, v9
    v_mul_u32_u24 v10, 20, v9
    v_sub_u32 v10, v8, v10
    v_and_b32 v6, 31, v9
    v_lshlrev_b32 v6, 6, v6
    v_and_b32 v11, 32, v9
    v_add3_u32 v6, v6, v11, s44
    v_mul_u32_u24 v6, 1280, v6
    v_lshl_add_u32 v6, v10, 3, v6
    v_mul_u32_u24 v4, 176, v9
    v_lshl_add_u32 v4, v10, 3, v4
    v_add_u32 v8, 64, v8
    v_mul_u32_u24 v9, s50, v8
    v_lshrrev_b32 v9, 16, v9
    v_mul_u32_u24 v10, 20, v9
    v_sub_u32 v10, v8, v10
    v_and_b32 v7, 31, v9
    v_lshlrev_b32 v7, 6, v7
    v_and_b32 v11, 32, v9
    v_add3_u32 v7, v7, v11, s44
    v_mul_u32_u24 v7, 1280, v7
    v_lshl_add_u32 v7, v10, 3, v7
    v_mul_u32_u24 v5, 176, v9
    v_lshl_add_u32 v5, v10, 3, v5
    s_mul_i32 s59, s45, 160
    s_mov_b32 s32, s82
    s_and_b32 s33, s83, 0xffff
    s_mov_b32 s34, 2621440
    s_mov_b32 s35, 0x00020000
    v_mov_b32 v176, 0
    v_mov_b32 v177, 0
    v_mov_b32 v178, 0
    v_mov_b32 v179, 0
    v_mov_b32 v180, 0
    v_mov_b32 v181, 0
    v_mov_b32 v182, 0
    v_mov_b32 v183, 0
    v_mov_b32 v184, 0
    v_mov_b32 v185, 0
    v_mov_b32 v186, 0
    v_mov_b32 v187, 0
    v_mov_b32 v188, 0
    v_mov_b32 v189, 0
    v_mov_b32 v190, 0
    v_mov_b32 v191, 0
    v_mov_b32 v192, 0
    v_mov_b32 v193, 0
    v_mov_b32 v194, 0
    v_mov_b32 v195, 0
    v_mov_b32 v196, 0
    v_mov_b32 v197, 0
    v_mov_b32 v198, 0
    v_mov_b32 v199, 0
    v_mov_b32 v200, 0
    v_mov_b32 v201, 0
    v_mov_b32 v202, 0
    v_mov_b32 v203, 0
    v_mov_b32 v204, 0
    v_mov_b32 v205, 0
    v_mov_b32 v206, 0
    v_mov_b32 v207, 0
    v_mov_b32 v208, 0
    v_mov_b32 v209, 0
    v_mov_b32 v210, 0
    v_mov_b32 v211, 0
    v_mov_b32 v212, 0
    v_mov_b32 v213, 0
    v_mov_b32 v214, 0
    v_mov_b32 v215, 0
    v_mov_b32 v216, 0
    v_mov_b32 v217, 0
    v_mov_b32 v218, 0
    v_mov_b32 v219, 0
    v_mov_b32 v220, 0
    v_mov_b32 v221, 0
    v_mov_b32 v222, 0
    v_mov_b32 v223, 0
    v_mov_b32 v224, 0
    v_mov_b32 v225, 0
    v_mov_b32 v226, 0
    v_mov_b32 v227, 0
    v_mov_b32 v228, 0
    v_mov_b32 v229, 0
    v_mov_b32 v230, 0
    v_mov_b32 v231, 0
    v_mov_b32 v232, 0
    v_mov_b32 v233, 0
    v_mov_b32 v234, 0
    v_mov_b32 v235, 0
    v_mov_b32 v236, 0
    v_mov_b32 v237, 0
    v_mov_b32 v238, 0
    v_mov_b32 v239, 0
    v_mov_b32 v240, 0
    v_mov_b32 v241, 0
    v_mov_b32 v242, 0
    v_mov_b32 v243, 0
    v_mov_b32 v244, 0
    v_mov_b32 v245, 0
    v_mov_b32 v246, 0
    v_mov_b32 v247, 0
    v_mov_b32 v248, 0
    v_mov_b32 v249, 0
    v_mov_b32 v250, 0
    v_mov_b32 v251, 0
    v_mov_b32 v252, 0
    v_mov_b32 v253, 0
    v_mov_b32 v254, 0
    v_mov_b32 v255, 0
    v_lshlrev_b32 v1, 4, v0
    s_lshl_b32 s50, s42, 3
    s_cmp_eq_u32 s42, 3
    s_cselect_b32 s50, 23, s50
    s_mul_i32 s55, s50, 5120
    v_add_u32 v3, s55, v1
    s_lshl_b32 s61, s50, 17
    s_lshl_b32 s62, s44, 12
    s_add_u32 s61, s61, s62
    s_add_u32 s61, s61, 4194304
    s_cmp_lt_u32 s42, 2
    s_cselect_b32 s62, 8, 7
    s_cmp_ge_u32 s39, s62
    s_cselect_b32 s63, 0, s39
    v_mov_b32 v8, 162328
    s_mov_b32 s60, 0
L_cs1:
    ds_read_b32 v9, v8
    s_add_u32 s60, s60, 1
    s_waitcnt lgkmcnt(0)
    v_cmp_gt_u32 vcc, 1, v9
    s_cbranch_vccz L_cs1d
    s_sleep 1
    s_cmp_lt_u32 s60, 0x400000
    s_cbranch_scc1 L_cs1
L_cs1d:
    s_mov_b32 s58, s63
    s_lshl_b32 s52, s63, 17
    s_add_u32 s52, s52, s61
    buffer_load_dwordx4 v[48:51], v1, s[16:19], s52 offen offset:0 sc1
    buffer_load_dwordx4 v[52:55], v1, s[16:19], s52 offen offset:1024 sc1
    buffer_load_dwordx4 v[56:59], v1, s[16:19], s52 offen offset:2048 sc1
    buffer_load_dwordx4 v[60:63], v1, s[16:19], s52 offen offset:3072 sc1
    s_add_u32 s63, s63, 1
    s_cmp_eq_u32 s63, s62
    s_cselect_b32 s63, 0, s63
    s_lshl_b32 s52, s63, 17
    s_add_u32 s52, s52, s61
    buffer_load_dwordx4 v[64:67], v1, s[16:19], s52 offen offset:0 sc1
    buffer_load_dwordx4 v[68:71], v1, s[16:19], s52 offen offset:1024 sc1
    buffer_load_dwordx4 v[72:75], v1, s[16:19], s52 offen offset:2048 sc1
    buffer_load_dwordx4 v[76:79], v1, s[16:19], s52 offen offset:3072 sc1
    s_add_u32 s63, s63, 1
    s_cmp_eq_u32 s63, s62
    s_cselect_b32 s63, 0, s63
    s_lshl_b32 s52, s63, 17
    s_add_u32 s52, s52, s61
    buffer_load_dwordx4 v[80:83], v1, s[16:19], s52 offen offset:0 sc1
    buffer_load_dwordx4 v[84:87], v1, s[16:19], s52 offen offset:1024 sc1
    buffer_load_dwordx4 v[88:91], v1, s[16:19], s52 offen offset:2048 sc1
    buffer_load_dwordx4 v[92:95], v1, s[16:19], s52 offen offset:3072 sc1
    s_add_u32 s63, s63, 1
    s_cmp_eq_u32 s63, s62
    s_cselect_b32 s63, 0, s63
    v_mov_b32 v8, 162332
    s_mov_b32 s60, 0
L_cwl:
    ds_read_b32 v9, v8
    s_add_u32 s60, s60, 1
    s_waitcnt lgkmcnt(0)
    v_cmp_gt_u32 vcc, 3, v9
    s_cbranch_vccz L_cwld
    s_sleep 1
    s_cmp_lt_u32 s60, 0x400000
    s_cbranch_scc1 L_cwl
L_cwld:
    s_mul_i32 s52, s58, 5120
    v_add_u32 v2, s52, v3
    s_add_u32 s58, s58, 1
    s_cmp_eq_u32 s58, s62
    s_cselect_b32 s58, 0, s58
    ds_read_b128 v[8:11], v2 offset:0
    ds_read_b128 v[12:15], v2 offset:1024
    ds_read_b128 v[16:19], v2 offset:2048
    ds_read_b128 v[20:23], v2 offset:3072
    ds_read_b128 v[24:27], v2 offset:4096
    s_waitcnt vmcnt(8) lgkmcnt(0)
    v_mfma_f32_16x16x32_bf16 v[176:179], v[8:11], v[48:51], v[176:179]
    s_mul_i32 s52, s58, 5120
    v_mfma_f32_16x16x32_bf16 v[180:183], v[8:11], v[52:55], v[180:183]
    v_add_u32 v2, s52, v3
    v_mfma_f32_16x16x32_bf16 v[184:187], v[8:11], v[56:59], v[184:187]
    s_add_u32 s58, s58, 1
    v_mfma_f32_16x16x32_bf16 v[188:191], v[8:11], v[60:63], v[188:191]
    s_cmp_eq_u32 s58, s62
    v_mfma_f32_16x16x32_bf16 v[192:195], v[12:15], v[48:51], v[192:195]
    s_cselect_b32 s58, 0, s58
    v_mfma_f32_16x16x32_bf16 v[196:199], v[12:15], v[52:55], v[196:199]
    ds_read_b128 v[28:31], v2 offset:0
    v_mfma_f32_16x16x32_bf16 v[200:203], v[12:15], v[56:59], v[200:203]
    ds_read_b128 v[32:35], v2 offset:1024
    v_mfma_f32_16x16x32_bf16 v[204:207], v[12:15], v[60:63], v[204:207]
    ds_read_b128 v[36:39], v2 offset:2048
    v_mfma_f32_16x16x32_bf16 v[208:211], v[16:19], v[48:51], v[208:211]
    ds_read_b128 v[40:43], v2 offset:3072
    v_mfma_f32_16x16x32_bf16 v[212:215], v[16:19], v[52:55], v[212:215]
    ds_read_b128 v[44:47], v2 offset:4096
    v_mfma_f32_16x16x32_bf16 v[216:219], v[16:19], v[56:59], v[216:219]
    s_lshl_b32 s52, s63, 17
    v_mfma_f32_16x16x32_bf16 v[220:223], v[16:19], v[60:63], v[220:223]
    s_add_u32 s52, s52, s61
    v_mfma_f32_16x16x32_bf16 v[224:227], v[20:23], v[48:51], v[224:227]
    buffer_load_dwordx4 v[96:99], v1, s[16:19], s52 offen offset:0 sc1
    v_mfma_f32_16x16x32_bf16 v[228:231], v[20:23], v[52:55], v[228:231]
    buffer_load_dwordx4 v[100:103], v1, s[16:19], s52 offen offset:1024 sc1
    v_mfma_f32_16x16x32_bf16 v[232:235], v[20:23], v[56:59], v[232:235]
    buffer_load_dwordx4 v[104:107], v1, s[16:19], s52 offen offset:2048 sc1
    v_mfma_f32_16x16x32_bf16 v[236:239], v[20:23], v[60:63], v[236:239]
    buffer_load_dwordx4 v[108:111], v1, s[16:19], s52 offen offset:3072 sc1
    v_mfma_f32_16x16x32_bf16 v[240:243], v[24:27], v[48:51], v[240:243]
    s_add_u32 s63, s63, 1
    v_mfma_f32_16x16x32_bf16 v[244:247], v[24:27], v[52:55], v[244:247]
    s_cmp_eq_u32 s63, s62
    v_mfma_f32_16x16x32_bf16 v[248:251], v[24:27], v[56:59], v[248:251]
    s_cselect_b32 s63, 0, s63
    v_mfma_f32_16x16x32_bf16 v[252:255], v[24:27], v[60:63], v[252:255]
    s_waitcnt vmcnt(8) lgkmcnt(0)
    v_mfma_f32_16x16x32_bf16 v[176:179], v[28:31], v[64:67], v[176:179]
    s_mul_i32 s52, s58, 5120
    v_mfma_f32_16x16x32_bf16 v[180:183], v[28:31], v[68:71], v[180:183]
    v_add_u32 v2, s52, v3
    v_mfma_f32_16x16x32_bf16 v[184:187], v[28:31], v[72:75], v[184:187]
    s_add_u32 s58, s58, 1
    v_mfma_f32_16x16x32_bf16 v[188:191], v[28:31], v[76:79], v[188:191]
    s_cmp_eq_u32 s58, s62
    v_mfma_f32_16x16x32_bf16 v[192:195], v[32:35], v[64:67], v[192:195]
    s_cselect_b32 s58, 0, s58
    v_mfma_f32_16x16x32_bf16 v[196:199], v[32:35], v[68:71], v[196:199]
    ds_read_b128 v[8:11], v2 offset:0
    v_mfma_f32_16x16x32_bf16 v[200:203], v[32:35], v[72:75], v[200:203]
    ds_read_b128 v[12:15], v2 offset:1024
    v_mfma_f32_16x16x32_bf16 v[204:207], v[32:35], v[76:79], v[204:207]
    ds_read_b128 v[16:19], v2 offset:2048
    v_mfma_f32_16x16x32_bf16 v[208:211], v[36:39], v[64:67], v[208:211]
    ds_read_b128 v[20:23], v2 offset:3072
    v_mfma_f32_16x16x32_bf16 v[212:215], v[36:39], v[68:71], v[212:215]
    ds_read_b128 v[24:27], v2 offset:4096
    v_mfma_f32_16x16x32_bf16 v[216:219], v[36:39], v[72:75], v[216:219]
    s_lshl_b32 s52, s63, 17
    v_mfma_f32_16x16x32_bf16 v[220:223], v[36:39], v[76:79], v[220:223]
    s_add_u32 s52, s52, s61
    v_mfma_f32_16x16x32_bf16 v[224:227], v[40:43], v[64:67], v[224:227]
    buffer_load_dwordx4 v[112:115], v1, s[16:19], s52 offen offset:0 sc1
    v_mfma_f32_16x16x32_bf16 v[228:231], v[40:43], v[68:71], v[228:231]
    buffer_load_dwordx4 v[116:119], v1, s[16:19], s52 offen offset:1024 sc1
    v_mfma_f32_16x16x32_bf16 v[232:235], v[40:43], v[72:75], v[232:235]
    buffer_load_dwordx4 v[120:123], v1, s[16:19], s52 offen offset:2048 sc1
    v_mfma_f32_16x16x32_bf16 v[236:239], v[40:43], v[76:79], v[236:239]
    buffer_load_dwordx4 v[124:127], v1, s[16:19], s52 offen offset:3072 sc1
    v_mfma_f32_16x16x32_bf16 v[240:243], v[44:47], v[64:67], v[240:243]
    s_add_u32 s63, s63, 1
    v_mfma_f32_16x16x32_bf16 v[244:247], v[44:47], v[68:71], v[244:247]
    s_cmp_eq_u32 s63, s62
    v_mfma_f32_16x16x32_bf16 v[248:251], v[44:47], v[72:75], v[248:251]
    s_cselect_b32 s63, 0, s63
    v_mfma_f32_16x16x32_bf16 v[252:255], v[44:47], v[76:79], v[252:255]
    s_waitcnt vmcnt(8) lgkmcnt(0)
    v_mfma_f32_16x16x32_bf16 v[176:179], v[8:11], v[80:83], v[176:179]
    s_mul_i32 s52, s58, 5120
    v_mfma_f32_16x16x32_bf16 v[180:183], v[8:11], v[84:87], v[180:183]
    v_add_u32 v2, s52, v3
    v_mfma_f32_16x16x32_bf16 v[184:187], v[8:11], v[88:91], v[184:187]
    s_add_u32 s58, s58, 1
    v_mfma_f32_16x16x32_bf16 v[188:191], v[8:11], v[92:95], v[188:191]
    s_cmp_eq_u32 s58, s62
    v_mfma_f32_16x16x32_bf16 v[192:195], v[12:15], v[80:83], v[192:195]
    s_cselect_b32 s58, 0, s58
    v_mfma_f32_16x16x32_bf16 v[196:199], v[12:15], v[84:87], v[196:199]
    ds_read_b128 v[28:31], v2 offset:0
    v_mfma_f32_16x16x32_bf16 v[200:203], v[12:15], v[88:91], v[200:203]
    ds_read_b128 v[32:35], v2 offset:1024
    v_mfma_f32_16x16x32_bf16 v[204:207], v[12:15], v[92:95], v[204:207]
    ds_read_b128 v[36:39], v2 offset:2048
    v_mfma_f32_16x16x32_bf16 v[208:211], v[16:19], v[80:83], v[208:211]
    ds_read_b128 v[40:43], v2 offset:3072
    v_mfma_f32_16x16x32_bf16 v[212:215], v[16:19], v[84:87], v[212:215]
    ds_read_b128 v[44:47], v2 offset:4096
    v_mfma_f32_16x16x32_bf16 v[216:219], v[16:19], v[88:91], v[216:219]
    s_lshl_b32 s52, s63, 17
    v_mfma_f32_16x16x32_bf16 v[220:223], v[16:19], v[92:95], v[220:223]
    s_add_u32 s52, s52, s61
    v_mfma_f32_16x16x32_bf16 v[224:227], v[20:23], v[80:83], v[224:227]
    buffer_load_dwordx4 v[128:131], v1, s[16:19], s52 offen offset:0 sc1
    v_mfma_f32_16x16x32_bf16 v[228:231], v[20:23], v[84:87], v[228:231]
    buffer_load_dwordx4 v[132:135], v1, s[16:19], s52 offen offset:1024 sc1
    v_mfma_f32_16x16x32_bf16 v[232:235], v[20:23], v[88:91], v[232:235]
    buffer_load_dwordx4 v[136:139], v1, s[16:19], s52 offen offset:2048 sc1
    v_mfma_f32_16x16x32_bf16 v[236:239], v[20:23], v[92:95], v[236:239]
    buffer_load_dwordx4 v[140:143], v1, s[16:19], s52 offen offset:3072 sc1
    v_mfma_f32_16x16x32_bf16 v[240:243], v[24:27], v[80:83], v[240:243]
    s_add_u32 s63, s63, 1
    v_mfma_f32_16x16x32_bf16 v[244:247], v[24:27], v[84:87], v[244:247]
    s_cmp_eq_u32 s63, s62
    v_mfma_f32_16x16x32_bf16 v[248:251], v[24:27], v[88:91], v[248:251]
    s_cselect_b32 s63, 0, s63
    v_mfma_f32_16x16x32_bf16 v[252:255], v[24:27], v[92:95], v[252:255]
    s_waitcnt vmcnt(8) lgkmcnt(0)
    v_mfma_f32_16x16x32_bf16 v[176:179], v[28:31], v[96:99], v[176:179]
    s_mul_i32 s52, s58, 5120
    v_mfma_f32_16x16x32_bf16 v[180:183], v[28:31], v[100:103], v[180:183]
    v_add_u32 v2, s52, v3
    v_mfma_f32_16x16x32_bf16 v[184:187], v[28:31], v[104:107], v[184:187]
    s_add_u32 s58, s58, 1
    v_mfma_f32_16x16x32_bf16 v[188:191], v[28:31], v[108:111], v[188:191]
    s_cmp_eq_u32 s58, s62
    v_mfma_f32_16x16x32_bf16 v[192:195], v[32:35], v[96:99], v[192:195]
    s_cselect_b32 s58, 0, s58
    v_mfma_f32_16x16x32_bf16 v[196:199], v[32:35], v[100:103], v[196:199]
    ds_read_b128 v[8:11], v2 offset:0
    v_mfma_f32_16x16x32_bf16 v[200:203], v[32:35], v[104:107], v[200:203]
    ds_read_b128 v[12:15], v2 offset:1024
    v_mfma_f32_16x16x32_bf16 v[204:207], v[32:35], v[108:111], v[204:207]
    ds_read_b128 v[16:19], v2 offset:2048
    v_mfma_f32_16x16x32_bf16 v[208:211], v[36:39], v[96:99], v[208:211]
    ds_read_b128 v[20:23], v2 offset:3072
    v_mfma_f32_16x16x32_bf16 v[212:215], v[36:39], v[100:103], v[212:215]
    ds_read_b128 v[24:27], v2 offset:4096
    v_mfma_f32_16x16x32_bf16 v[216:219], v[36:39], v[104:107], v[216:219]
    s_lshl_b32 s52, s63, 17
    v_mfma_f32_16x16x32_bf16 v[220:223], v[36:39], v[108:111], v[220:223]
    s_add_u32 s52, s52, s61
    v_mfma_f32_16x16x32_bf16 v[224:227], v[40:43], v[96:99], v[224:227]
    buffer_load_dwordx4 v[144:147], v1, s[16:19], s52 offen offset:0 sc1
    v_mfma_f32_16x16x32_bf16 v[228:231], v[40:43], v[100:103], v[228:231]
    buffer_load_dwordx4 v[148:151], v1, s[16:19], s52 offen offset:1024 sc1
    v_mfma_f32_16x16x32_bf16 v[232:235], v[40:43], v[104:107], v[232:235]
    buffer_load_dwordx4 v[152:155], v1, s[16:19], s52 offen offset:2048 sc1
    v_mfma_f32_16x16x32_bf16 v[236:239], v[40:43], v[108:111], v[236:239]
    buffer_load_dwordx4 v[156:159], v1, s[16:19], s52 offen offset:3072 sc1
    v_mfma_f32_16x16x32_bf16 v[240:243], v[44:47], v[96:99], v[240:243]
    s_add_u32 s63, s63, 1
    v_mfma_f32_16x16x32_bf16 v[244:247], v[44:47], v[100:103], v[244:247]
    s_cmp_eq_u32 s63, s62
    v_mfma_f32_16x16x32_bf16 v[248:251], v[44:47], v[104:107], v[248:251]
    s_cselect_b32 s63, 0, s63
    v_mfma_f32_16x16x32_bf16 v[252:255], v[44:47], v[108:111], v[252:255]
    s_waitcnt vmcnt(8) lgkmcnt(0)
    v_mfma_f32_16x16x32_bf16 v[176:179], v[8:11], v[112:115], v[176:179]
    s_mul_i32 s52, s58, 5120
    v_mfma_f32_16x16x32_bf16 v[180:183], v[8:11], v[116:119], v[180:183]
    v_add_u32 v2, s52, v3
    v_mfma_f32_16x16x32_bf16 v[184:187], v[8:11], v[120:123], v[184:187]
    s_add_u32 s58, s58, 1
    v_mfma_f32_16x16x32_bf16 v[188:191], v[8:11], v[124:127], v[188:191]
    s_cmp_eq_u32 s58, s62
    v_mfma_f32_16x16x32_bf16 v[192:195], v[12:15], v[112:115], v[192:195]
    s_cselect_b32 s58, 0, s58
    v_mfma_f32_16x16x32_bf16 v[196:199], v[12:15], v[116:119], v[196:199]
    ds_read_b128 v[28:31], v2 offset:0
    v_mfma_f32_16x16x32_bf16 v[200:203], v[12:15], v[120:123], v[200:203]
    ds_read_b128 v[32:35], v2 offset:1024
    v_mfma_f32_16x16x32_bf16 v[204:207], v[12:15], v[124:127], v[204:207]
    ds_read_b128 v[36:39], v2 offset:2048
    v_mfma_f32_16x16x32_bf16 v[208:211], v[16:19], v[112:115], v[208:211]
    ds_read_b128 v[40:43], v2 offset:3072
    v_mfma_f32_16x16x32_bf16 v[212:215], v[16:19], v[116:119], v[212:215]
    ds_read_b128 v[44:47], v2 offset:4096
    v_mfma_f32_16x16x32_bf16 v[216:219], v[16:19], v[120:123], v[216:219]
    s_lshl_b32 s52, s63, 17
    v_mfma_f32_16x16x32_bf16 v[220:223], v[16:19], v[124:127], v[220:223]
    s_add_u32 s52, s52, s61
    v_mfma_f32_16x16x32_bf16 v[224:227], v[20:23], v[112:115], v[224:227]
    s_cmp_lt_u32 s42, 2
    v_mfma_f32_16x16x32_bf16 v[228:231], v[20:23], v[116:119], v[228:231]
    s_cselect_b32 s52, s52, 0x40000000
    v_mfma_f32_16x16x32_bf16 v[232:235], v[20:23], v[120:123], v[232:235]
    buffer_load_dwordx4 v[160:163], v1, s[16:19], s52 offen offset:0 sc1
    v_mfma_f32_16x16x32_bf16 v[236:239], v[20:23], v[124:127], v[236:239]
    buffer_load_dwordx4 v[164:167], v1, s[16:19], s52 offen offset:1024 sc1
    v_mfma_f32_16x16x32_bf16 v[240:243], v[24:27], v[112:115], v[240:243]
    buffer_load_dwordx4 v[168:171], v1, s[16:19], s52 offen offset:2048 sc1
    v_mfma_f32_16x16x32_bf16 v[244:247], v[24:27], v[116:119], v[244:247]
    buffer_load_dwordx4 v[172:175], v1, s[16:19], s52 offen offset:3072 sc1
    v_mfma_f32_16x16x32_bf16 v[248:251], v[24:27], v[120:123], v[248:251]
    s_add_u32 s63, s63, 1
    v_mfma_f32_16x16x32_bf16 v[252:255], v[24:27], v[124:127], v[252:255]
    s_cmp_eq_u32 s63, s62
    s_cselect_b32 s63, 0, s63
    s_waitcnt vmcnt(8) lgkmcnt(0)
    v_mfma_f32_16x16x32_bf16 v[176:179], v[28:31], v[128:131], v[176:179]
    s_mul_i32 s52, s58, 5120
    v_mfma_f32_16x16x32_bf16 v[180:183], v[28:31], v[132:135], v[180:183]
    v_add_u32 v2, s52, v3
    v_mfma_f32_16x16x32_bf16 v[184:187], v[28:31], v[136:139], v[184:187]
    s_add_u32 s58, s58, 1
    v_mfma_f32_16x16x32_bf16 v[188:191], v[28:31], v[140:143], v[188:191]
    s_cmp_eq_u32 s58, s62
    v_mfma_f32_16x16x32_bf16 v[192:195], v[32:35], v[128:131], v[192:195]
    s_cselect_b32 s58, 0, s58
    v_mfma_f32_16x16x32_bf16 v[196:199], v[32:35], v[132:135], v[196:199]
    ds_read_b128 v[8:11], v2 offset:0
    v_mfma_f32_16x16x32_bf16 v[200:203], v[32:35], v[136:139], v[200:203]
    ds_read_b128 v[12:15], v2 offset:1024
    v_mfma_f32_16x16x32_bf16 v[204:207], v[32:35], v[140:143], v[204:207]
    ds_read_b128 v[16:19], v2 offset:2048
    v_mfma_f32_16x16x32_bf16 v[208:211], v[36:39], v[128:131], v[208:211]
    ds_read_b128 v[20:23], v2 offset:3072
    v_mfma_f32_16x16x32_bf16 v[212:215], v[36:39], v[132:135], v[212:215]
    ds_read_b128 v[24:27], v2 offset:4096
    v_mfma_f32_16x16x32_bf16 v[216:219], v[36:39], v[136:139], v[216:219]
    v_mfma_f32_16x16x32_bf16 v[220:223], v[36:39], v[140:143], v[220:223]
    v_mfma_f32_16x16x32_bf16 v[224:227], v[40:43], v[128:131], v[224:227]
    v_mfma_f32_16x16x32_bf16 v[228:231], v[40:43], v[132:135], v[228:231]
    v_mfma_f32_16x16x32_bf16 v[232:235], v[40:43], v[136:139], v[232:235]
    v_mfma_f32_16x16x32_bf16 v[236:239], v[40:43], v[140:143], v[236:239]
    v_mfma_f32_16x16x32_bf16 v[240:243], v[44:47], v[128:131], v[240:243]
    v_mfma_f32_16x16x32_bf16 v[244:247], v[44:47], v[132:135], v[244:247]
    v_mfma_f32_16x16x32_bf16 v[248:251], v[44:47], v[136:139], v[248:251]
    v_mfma_f32_16x16x32_bf16 v[252:255], v[44:47], v[140:143], v[252:255]
    s_mul_i32 s52, s58, 5120
    v_add_u32 v2, s52, v3
    s_add_u32 s58, s58, 1
    s_cmp_eq_u32 s58, s62
    s_cselect_b32 s58, 0, s58
    ds_read_b128 v[28:31], v2 offset:0
    ds_read_b128 v[32:35], v2 offset:1024
    ds_read_b128 v[36:39], v2 offset:2048
    ds_read_b128 v[40:43], v2 offset:3072
    ds_read_b128 v[44:47], v2 offset:4096
    v_and_b32 v56, 15, v0
    v_lshrrev_b32 v57, 4, v0
    v_mul_u32_u24 v56, 176, v56
    v_lshl_add_u32 v56, v57, 3, v56
    s_lshl_b32 s50, s42, 2
    s_add_u32 s50, s50, 162336
    v_mov_b32 v57, s50
    v_mov_b32 v58, 1
    s_waitcnt vmcnt(0) lgkmcnt(0)
    ds_write_b32 v57, v58
    v_add_u32 v2, s55, v56
    v_mfma_f32_16x16x32_bf16 v[176:179], v[8:11], v[144:147], v[176:179]
    v_mfma_f32_16x16x32_bf16 v[180:183], v[8:11], v[148:151], v[180:183]
    v_mfma_f32_16x16x32_bf16 v[184:187], v[8:11], v[152:155], v[184:187]
    v_mfma_f32_16x16x32_bf16 v[188:191], v[8:11], v[156:159], v[188:191]
    v_mfma_f32_16x16x32_bf16 v[176:179], v[28:31], v[160:163], v[176:179]
    v_mfma_f32_16x16x32_bf16 v[180:183], v[28:31], v[164:167], v[180:183]
    v_mfma_f32_16x16x32_bf16 v[184:187], v[28:31], v[168:171], v[184:187]
    v_mfma_f32_16x16x32_bf16 v[188:191], v[28:31], v[172:175], v[188:191]
    v_mfma_f32_16x16x32_bf16 v[192:195], v[12:15], v[144:147], v[192:195]
    v_mfma_f32_16x16x32_bf16 v[196:199], v[12:15], v[148:151], v[196:199]
    v_mfma_f32_16x16x32_bf16 v[200:203], v[12:15], v[152:155], v[200:203]
    v_mfma_f32_16x16x32_bf16 v[204:207], v[12:15], v[156:159], v[204:207]
    v_mfma_f32_16x16x32_bf16 v[192:195], v[32:35], v[160:163], v[192:195]
    v_cvt_pk_bf16_f32 v176, v176, v177
    v_cvt_pk_bf16_f32 v177, v178, v179
    ds_write_b64 v2, v[176:177] offset:0
    v_mfma_f32_16x16x32_bf16 v[196:199], v[32:35], v[164:167], v[196:199]
    v_cvt_pk_bf16_f32 v180, v180, v181
    v_cvt_pk_bf16_f32 v181, v182, v183
    ds_write_b64 v2, v[180:181] offset:2816
    v_mfma_f32_16x16x32_bf16 v[200:203], v[32:35], v[168:171], v[200:203]
    v_cvt_pk_bf16_f32 v184, v184, v185
    v_cvt_pk_bf16_f32 v185, v186, v187
    ds_write_b64 v2, v[184:185] offset:5632
    v_mfma_f32_16x16x32_bf16 v[204:207], v[32:35], v[172:175], v[204:207]
    v_cvt_pk_bf16_f32 v188, v188, v189
    v_cvt_pk_bf16_f32 v189, v190, v191
    ds_write_b64 v2, v[188:189] offset:8448
    v_mfma_f32_16x16x32_bf16 v[208:211], v[16:19], v[144:147], v[208:211]
    v_mfma_f32_16x16x32_bf16 v[212:215], v[16:19], v[148:151], v[212:215]
    v_mfma_f32_16x16x32_bf16 v[216:219], v[16:19], v[152:155], v[216:219]
    v_mfma_f32_16x16x32_bf16 v[220:223], v[16:19], v[156:159], v[220:223]
    v_mfma_f32_16x16x32_bf16 v[208:211], v[36:39], v[160:163], v[208:211]
    v_cvt_pk_bf16_f32 v192, v192, v193
    v_cvt_pk_bf16_f32 v193, v194, v195
    ds_write_b64 v2, v[192:193] offset:32
    v_mfma_f32_16x16x32_bf16 v[212:215], v[36:39], v[164:167], v[212:215]
    v_cvt_pk_bf16_f32 v196, v196, v197
    v_cvt_pk_bf16_f32 v197, v198, v199
    ds_write_b64 v2, v[196:197] offset:2848
    v_mfma_f32_16x16x32_bf16 v[216:219], v[36:39], v[168:171], v[216:219]
    v_cvt_pk_bf16_f32 v200, v200, v201
    v_cvt_pk_bf16_f32 v201, v202, v203
    ds_write_b64 v2, v[200:201] offset:5664
    v_mfma_f32_16x16x32_bf16 v[220:223], v[36:39], v[172:175], v[220:223]
    v_cvt_pk_bf16_f32 v204, v204, v205
    v_cvt_pk_bf16_f32 v205, v206, v207
    ds_write_b64 v2, v[204:205] offset:8480
    v_mfma_f32_16x16x32_bf16 v[224:227], v[20:23], v[144:147], v[224:227]
    v_mfma_f32_16x16x32_bf16 v[228:231], v[20:23], v[148:151], v[228:231]
    v_mfma_f32_16x16x32_bf16 v[232:235], v[20:23], v[152:155], v[232:235]
    v_mfma_f32_16x16x32_bf16 v[236:239], v[20:23], v[156:159], v[236:239]
    v_mfma_f32_16x16x32_bf16 v[224:227], v[40:43], v[160:163], v[224:227]
    v_cvt_pk_bf16_f32 v208, v208, v209
    v_cvt_pk_bf16_f32 v209, v210, v211
    ds_write_b64 v2, v[208:209] offset:64
    v_mfma_f32_16x16x32_bf16 v[228:231], v[40:43], v[164:167], v[228:231]
    v_cvt_pk_bf16_f32 v212, v212, v213
    v_cvt_pk_bf16_f32 v213, v214, v215
    ds_write_b64 v2, v[212:213] offset:2880
    v_mfma_f32_16x16x32_bf16 v[232:235], v[40:43], v[168:171], v[232:235]
    v_cvt_pk_bf16_f32 v216, v216, v217
    v_cvt_pk_bf16_f32 v217, v218, v219
    ds_write_b64 v2, v[216:217] offset:5696
    v_mfma_f32_16x16x32_bf16 v[236:239], v[40:43], v[172:175], v[236:239]
    v_cvt_pk_bf16_f32 v220, v220, v221
    v_cvt_pk_bf16_f32 v221, v222, v223
    ds_write_b64 v2, v[220:221] offset:8512
    v_mfma_f32_16x16x32_bf16 v[240:243], v[24:27], v[144:147], v[240:243]
    v_mfma_f32_16x16x32_bf16 v[244:247], v[24:27], v[148:151], v[244:247]
    v_mfma_f32_16x16x32_bf16 v[248:251], v[24:27], v[152:155], v[248:251]
    v_mfma_f32_16x16x32_bf16 v[252:255], v[24:27], v[156:159], v[252:255]
    v_mfma_f32_16x16x32_bf16 v[240:243], v[44:47], v[160:163], v[240:243]
    v_cvt_pk_bf16_f32 v224, v224, v225
    v_cvt_pk_bf16_f32 v225, v226, v227
    ds_write_b64 v2, v[224:225] offset:96
    v_mfma_f32_16x16x32_bf16 v[244:247], v[44:47], v[164:167], v[244:247]
    v_cvt_pk_bf16_f32 v228, v228, v229
    v_cvt_pk_bf16_f32 v229, v230, v231
    ds_write_b64 v2, v[228:229] offset:2912
    v_mfma_f32_16x16x32_bf16 v[248:251], v[44:47], v[168:171], v[248:251]
    v_cvt_pk_bf16_f32 v232, v232, v233
    v_cvt_pk_bf16_f32 v233, v234, v235
    ds_write_b64 v2, v[232:233] offset:5728
    v_mfma_f32_16x16x32_bf16 v[252:255], v[44:47], v[172:175], v[252:255]
    v_cvt_pk_bf16_f32 v236, v236, v237
    v_cvt_pk_bf16_f32 v237, v238, v239
    ds_write_b64 v2, v[236:237] offset:8544
    s_nop 7
    v_cvt_pk_bf16_f32 v240, v240, v241
    v_cvt_pk_bf16_f32 v241, v242, v243
    ds_write_b64 v2, v[240:241] offset:128
    v_cvt_pk_bf16_f32 v244, v244, v245
    v_cvt_pk_bf16_f32 v245, v246, v247
    ds_write_b64 v2, v[244:245] offset:2944
    v_cvt_pk_bf16_f32 v248, v248, v249
    v_cvt_pk_bf16_f32 v249, v250, v251
    ds_write_b64 v2, v[248:249] offset:5760
    v_cvt_pk_bf16_f32 v252, v252, v253
    v_cvt_pk_bf16_f32 v253, v254, v255
    ds_write_b64 v2, v[252:253] offset:8576
    s_mov_b32 s50, 3277
    s_lshl_b32 s51, s42, 6
    s_add_u32 s51, s51, 1024
    v_add_u32 v64, s51, v0
    v_mul_u32_u24 v65, s50, v64
    v_lshrrev_b32 v65, 16, v65
    v_mul_u32_u24 v66, 20, v65
    v_sub_u32 v66, v64, v66
    v_and_b32 v9, 31, v65
    v_lshlrev_b32 v9, 6, v9
    v_and_b32 v67, 32, v65
    v_add3_u32 v9, v9, v67, s44
    v_mul_u32_u24 v9, 1280, v9
    v_lshl_add_u32 v9, v66, 3, v9
    v_mul_u32_u24 v8, 176, v65
    v_lshl_add_u32 v8, v66, 3, v8
L_final:
    v_add_u32 v16, 81920, v4
    v_add_u32 v17, 81920, v5
    v_add_u32 v18, 81920, v8
    s_waitcnt lgkmcnt(0)
    s_barrier
    ds_read_b64 v[64:65], v4 offset:0
    ds_read_b64 v[66:67], v4 offset:40960
    ds_read_b64 v[68:69], v16 offset:0
    ds_read_b64 v[70:71], v16 offset:35840
    ds_read_b64 v[72:73], v4 offset:11264
    ds_read_b64 v[74:75], v4 offset:52224
    ds_read_b64 v[76:77], v16 offset:11264
    ds_read_b64 v[78:79], v16 offset:47104
    ds_read_b64 v[80:81], v5 offset:0
    ds_read_b64 v[82:83], v5 offset:40960
    ds_read_b64 v[84:85], v17 offset:0
    ds_read_b64 v[86:87], v17 offset:35840
    ds_read_b64 v[88:89], v5 offset:11264
    ds_read_b64 v[90:91], v5 offset:52224
    ds_read_b64 v[92:93], v17 offset:11264
    ds_read_b64 v[94:95], v17 offset:47104
    s_cmp_ge_u32 s42, 4
    s_cbranch_scc1 L_fin2
    s_waitcnt lgkmcnt(8)
    ds_read_b64 v[96:97], v8 offset:0
    ds_read_b64 v[98:99], v8 offset:40960
    ds_read_b64 v[100:101], v18 offset:0
    ds_read_b64 v[102:103], v18 offset:35840
    ds_read_b64 v[104:105], v8 offset:11264
    ds_read_b64 v[106:107], v8 offset:52224
    ds_read_b64 v[108:109], v18 offset:11264
    ds_read_b64 v[110:111], v18 offset:47104
    v_lshlrev_b32 v32, 16, v64
    v_and_b32 v33, 0xffff0000, v64
    v_lshlrev_b32 v34, 16, v65
    v_and_b32 v35, 0xffff0000, v65
    v_lshlrev_b32 v36, 16, v66
    v_and_b32 v37, 0xffff0000, v66
    v_lshlrev_b32 v38, 16, v67
    v_and_b32 v39, 0xffff0000, v67
    v_lshlrev_b32 v20, 16, v68
    v_and_b32 v21, 0xffff0000, v68
    v_lshlrev_b32 v22, 16, v69
    v_and_b32 v23, 0xffff0000, v69
    v_lshlrev_b32 v24, 16, v70
    v_and_b32 v25, 0xffff0000, v70
    v_lshlrev_b32 v26, 16, v71
    v_and_b32 v27, 0xffff0000, v71
    v_pk_add_f32 v[32:33], v[32:33], v[20:21]
    v_pk_add_f32 v[34:35], v[34:35], v[22:23]
    v_pk_add_f32 v[36:37], v[36:37], v[24:25]
    v_pk_add_f32 v[38:39], v[38:39], v[26:27]
    v_lshlrev_b32 v20, 16, v72
    v_and_b32 v21, 0xffff0000, v72
    v_lshlrev_b32 v22, 16, v73
    v_and_b32 v23, 0xffff0000, v73
    v_lshlrev_b32 v24, 16, v74
    v_and_b32 v25, 0xffff0000, v74
    v_lshlrev_b32 v26, 16, v75
    v_and_b32 v27, 0xffff0000, v75
    v_pk_add_f32 v[32:33], v[32:33], v[20:21]
    v_pk_add_f32 v[34:35], v[34:35], v[22:23]
    v_pk_add_f32 v[36:37], v[36:37], v[24:25]
    v_pk_add_f32 v[38:39], v[38:39], v[26:27]
    v_lshlrev_b32 v20, 16, v76
    v_and_b32 v21, 0xffff0000, v76
    v_lshlrev_b32 v22, 16, v77
    v_and_b32 v23, 0xffff0000, v77
    v_lshlrev_b32 v24, 16, v78
    v_and_b32 v25, 0xffff0000, v78
    v_lshlrev_b32 v26, 16, v79
    v_and_b32 v27, 0xffff0000, v79
    v_pk_add_f32 v[32:33], v[32:33], v[20:21]
    v_pk_add_f32 v[34:35], v[34:35], v[22:23]
    v_pk_add_f32 v[36:37], v[36:37], v[24:25]
    v_pk_add_f32 v[38:39], v[38:39], v[26:27]
    v_pk_add_f32 v[32:33], v[32:33], v[36:37]
    v_pk_add_f32 v[34:35], v[34:35], v[38:39]
    v_cvt_pk_bf16_f32 v40, v32, v33
    v_cvt_pk_bf16_f32 v41, v34, v35
    buffer_store_dwordx2 v[40:41], v6, s[32:35], s59 offen sc1
    s_waitcnt lgkmcnt(8)
    v_lshlrev_b32 v44, 16, v80
    v_and_b32 v45, 0xffff0000, v80
    v_lshlrev_b32 v46, 16, v81
    v_and_b32 v47, 0xffff0000, v81
    v_lshlrev_b32 v48, 16, v82
    v_and_b32 v49, 0xffff0000, v82
    v_lshlrev_b32 v50, 16, v83
    v_and_b32 v51, 0xffff0000, v83
    v_lshlrev_b32 v20, 16, v84
    v_and_b32 v21, 0xffff0000, v84
    v_lshlrev_b32 v22, 16, v85
    v_and_b32 v23, 0xffff0000, v85
    v_lshlrev_b32 v24, 16, v86
    v_and_b32 v25, 0xffff0000, v86
    v_lshlrev_b32 v26, 16, v87
    v_and_b32 v27, 0xffff0000, v87
    v_pk_add_f32 v[44:45], v[44:45], v[20:21]
    v_pk_add_f32 v[46:47], v[46:47], v[22:23]
    v_pk_add_f32 v[48:49], v[48:49], v[24:25]
    v_pk_add_f32 v[50:51], v[50:51], v[26:27]
    v_lshlrev_b32 v20, 16, v88
    v_and_b32 v21, 0xffff0000, v88
    v_lshlrev_b32 v22, 16, v89
    v_and_b32 v23, 0xffff0000, v89
    v_lshlrev_b32 v24, 16, v90
    v_and_b32 v25, 0xffff0000, v90
    v_lshlrev_b32 v26, 16, v91
    v_and_b32 v27, 0xffff0000, v91
    v_pk_add_f32 v[44:45], v[44:45], v[20:21]
    v_pk_add_f32 v[46:47], v[46:47], v[22:23]
    v_pk_add_f32 v[48:49], v[48:49], v[24:25]
    v_pk_add_f32 v[50:51], v[50:51], v[26:27]
    v_lshlrev_b32 v20, 16, v92
    v_and_b32 v21, 0xffff0000, v92
    v_lshlrev_b32 v22, 16, v93
    v_and_b32 v23, 0xffff0000, v93
    v_lshlrev_b32 v24, 16, v94
    v_and_b32 v25, 0xffff0000, v94
    v_lshlrev_b32 v26, 16, v95
    v_and_b32 v27, 0xffff0000, v95
    v_pk_add_f32 v[44:45], v[44:45], v[20:21]
    v_pk_add_f32 v[46:47], v[46:47], v[22:23]
    v_pk_add_f32 v[48:49], v[48:49], v[24:25]
    v_pk_add_f32 v[50:51], v[50:51], v[26:27]
    v_pk_add_f32 v[44:45], v[44:45], v[48:49]
    v_pk_add_f32 v[46:47], v[46:47], v[50:51]
    v_cvt_pk_bf16_f32 v52, v44, v45
    v_cvt_pk_bf16_f32 v53, v46, v47
    buffer_store_dwordx2 v[52:53], v7, s[32:35], s59 offen sc1
    s_waitcnt lgkmcnt(0)
    v_lshlrev_b32 v32, 16, v96
    v_and_b32 v33, 0xffff0000, v96
    v_lshlrev_b32 v34, 16, v97
    v_and_b32 v35, 0xffff0000, v97
    v_lshlrev_b32 v36, 16, v98
    v_and_b32 v37, 0xffff0000, v98
    v_lshlrev_b32 v38, 16, v99
    v_and_b32 v39, 0xffff0000, v99
    v_lshlrev_b32 v20, 16, v100
    v_and_b32 v21, 0xffff0000, v100
    v_lshlrev_b32 v22, 16, v101
    v_and_b32 v23, 0xffff0000, v101
    v_lshlrev_b32 v24, 16, v102
    v_and_b32 v25, 0xffff0000, v102
    v_lshlrev_b32 v26, 16, v103
    v_and_b32 v27, 0xffff0000, v103
    v_pk_add_f32 v[32:33], v[32:33], v[20:21]
    v_pk_add_f32 v[34:35], v[34:35], v[22:23]
    v_pk_add_f32 v[36:37], v[36:37], v[24:25]
    v_pk_add_f32 v[38:39], v[38:39], v[26:27]
    v_lshlrev_b32 v20, 16, v104
    v_and_b32 v21, 0xffff0000, v104
    v_lshlrev_b32 v22, 16, v105
    v_and_b32 v23, 0xffff0000, v105
    v_lshlrev_b32 v24, 16, v106
    v_and_b32 v25, 0xffff0000, v106
    v_lshlrev_b32 v26, 16, v107
    v_and_b32 v27, 0xffff0000, v107
    v_pk_add_f32 v[32:33], v[32:33], v[20:21]
    v_pk_add_f32 v[34:35], v[34:35], v[22:23]
    v_pk_add_f32 v[36:37], v[36:37], v[24:25]
    v_pk_add_f32 v[38:39], v[38:39], v[26:27]
    v_lshlrev_b32 v20, 16, v108
    v_and_b32 v21, 0xffff0000, v108
    v_lshlrev_b32 v22, 16, v109
    v_and_b32 v23, 0xffff0000, v109
    v_lshlrev_b32 v24, 16, v110
    v_and_b32 v25, 0xffff0000, v110
    v_lshlrev_b32 v26, 16, v111
    v_and_b32 v27, 0xffff0000, v111
    v_pk_add_f32 v[32:33], v[32:33], v[20:21]
    v_pk_add_f32 v[34:35], v[34:35], v[22:23]
    v_pk_add_f32 v[36:37], v[36:37], v[24:25]
    v_pk_add_f32 v[38:39], v[38:39], v[26:27]
    v_pk_add_f32 v[32:33], v[32:33], v[36:37]
    v_pk_add_f32 v[34:35], v[34:35], v[38:39]
    v_cvt_pk_bf16_f32 v40, v32, v33
    v_cvt_pk_bf16_f32 v41, v34, v35
    buffer_store_dwordx2 v[40:41], v9, s[32:35], s59 offen sc1
    s_branch L_fin3
L_fin2:
    s_waitcnt lgkmcnt(8)
    v_lshlrev_b32 v32, 16, v64
    v_and_b32 v33, 0xffff0000, v64
    v_lshlrev_b32 v34, 16, v65
    v_and_b32 v35, 0xffff0000, v65
    v_lshlrev_b32 v36, 16, v66
    v_and_b32 v37, 0xffff0000, v66
    v_lshlrev_b32 v38, 16, v67
    v_and_b32 v39, 0xffff0000, v67
    v_lshlrev_b32 v20, 16, v68
    v_and_b32 v21, 0xffff0000, v68
    v_lshlrev_b32 v22, 16, v69
    v_and_b32 v23, 0xffff0000, v69
    v_lshlrev_b32 v24, 16, v70
    v_and_b32 v25, 0xffff0000, v70
    v_lshlrev_b32 v26, 16, v71
    v_and_b32 v27, 0xffff0000, v71
    v_pk_add_f32 v[32:33], v[32:33], v[20:21]
    v_pk_add_f32 v[34:35], v[34:35], v[22:23]
    v_pk_add_f32 v[36:37], v[36:37], v[24:25]
    v_pk_add_f32 v[38:39], v[38:39], v[26:27]
    v_lshlrev_b32 v20, 16, v72
    v_and_b32 v21, 0xffff0000, v72
    v_lshlrev_b32 v22, 16, v73
    v_and_b32 v23, 0xffff0000, v73
    v_lshlrev_b32 v24, 16, v74
    v_and_b32 v25, 0xffff0000, v74
    v_lshlrev_b32 v26, 16, v75
    v_and_b32 v27, 0xffff0000, v75
    v_pk_add_f32 v[32:33], v[32:33], v[20:21]
    v_pk_add_f32 v[34:35], v[34:35], v[22:23]
    v_pk_add_f32 v[36:37], v[36:37], v[24:25]
    v_pk_add_f32 v[38:39], v[38:39], v[26:27]
    v_lshlrev_b32 v20, 16, v76
    v_and_b32 v21, 0xffff0000, v76
    v_lshlrev_b32 v22, 16, v77
    v_and_b32 v23, 0xffff0000, v77
    v_lshlrev_b32 v24, 16, v78
    v_and_b32 v25, 0xffff0000, v78
    v_lshlrev_b32 v26, 16, v79
    v_and_b32 v27, 0xffff0000, v79
    v_pk_add_f32 v[32:33], v[32:33], v[20:21]
    v_pk_add_f32 v[34:35], v[34:35], v[22:23]
    v_pk_add_f32 v[36:37], v[36:37], v[24:25]
    v_pk_add_f32 v[38:39], v[38:39], v[26:27]
    v_pk_add_f32 v[32:33], v[32:33], v[36:37]
    v_pk_add_f32 v[34:35], v[34:35], v[38:39]
    v_cvt_pk_bf16_f32 v40, v32, v33
    v_cvt_pk_bf16_f32 v41, v34, v35
    buffer_store_dwordx2 v[40:41], v6, s[32:35], s59 offen sc1
    s_waitcnt lgkmcnt(0)
    v_lshlrev_b32 v44, 16, v80
    v_and_b32 v45, 0xffff0000, v80
    v_lshlrev_b32 v46, 16, v81
    v_and_b32 v47, 0xffff0000, v81
    v_lshlrev_b32 v48, 16, v82
    v_and_b32 v49, 0xffff0000, v82
    v_lshlrev_b32 v50, 16, v83
    v_and_b32 v51, 0xffff0000, v83
    v_lshlrev_b32 v20, 16, v84
    v_and_b32 v21, 0xffff0000, v84
    v_lshlrev_b32 v22, 16, v85
    v_and_b32 v23, 0xffff0000, v85
    v_lshlrev_b32 v24, 16, v86
    v_and_b32 v25, 0xffff0000, v86
    v_lshlrev_b32 v26, 16, v87
    v_and_b32 v27, 0xffff0000, v87
    v_pk_add_f32 v[44:45], v[44:45], v[20:21]
    v_pk_add_f32 v[46:47], v[46:47], v[22:23]
    v_pk_add_f32 v[48:49], v[48:49], v[24:25]
    v_pk_add_f32 v[50:51], v[50:51], v[26:27]
    v_lshlrev_b32 v20, 16, v88
    v_and_b32 v21, 0xffff0000, v88
    v_lshlrev_b32 v22, 16, v89
    v_and_b32 v23, 0xffff0000, v89
    v_lshlrev_b32 v24, 16, v90
    v_and_b32 v25, 0xffff0000, v90
    v_lshlrev_b32 v26, 16, v91
    v_and_b32 v27, 0xffff0000, v91
    v_pk_add_f32 v[44:45], v[44:45], v[20:21]
    v_pk_add_f32 v[46:47], v[46:47], v[22:23]
    v_pk_add_f32 v[48:49], v[48:49], v[24:25]
    v_pk_add_f32 v[50:51], v[50:51], v[26:27]
    v_lshlrev_b32 v20, 16, v92
    v_and_b32 v21, 0xffff0000, v92
    v_lshlrev_b32 v22, 16, v93
    v_and_b32 v23, 0xffff0000, v93
    v_lshlrev_b32 v24, 16, v94
    v_and_b32 v25, 0xffff0000, v94
    v_lshlrev_b32 v26, 16, v95
    v_and_b32 v27, 0xffff0000, v95
    v_pk_add_f32 v[44:45], v[44:45], v[20:21]
    v_pk_add_f32 v[46:47], v[46:47], v[22:23]
    v_pk_add_f32 v[48:49], v[48:49], v[24:25]
    v_pk_add_f32 v[50:51], v[50:51], v[26:27]
    v_pk_add_f32 v[44:45], v[44:45], v[48:49]
    v_pk_add_f32 v[46:47], v[46:47], v[50:51]
    v_cvt_pk_bf16_f32 v52, v44, v45
    v_cvt_pk_bf16_f32 v53, v46, v47
    buffer_store_dwordx2 v[52:53], v7, s[32:35], s59 offen sc1
L_fin3:
    s_cmp_lg_u32 s2, 0
    s_cbranch_scc1 L_noep
    s_cmp_lg_u32 s42, 7
    s_cbranch_scc1 L_noep
    s_mov_b64 exec, -1
    v_lshlrev_b32 v8, 9, v0
    s_mov_b32 s50, 3407872
    s_mov_b32 s60, 0
L_ep:
    buffer_load_dword v12, v8, s[16:19], s50 offen sc1
    buffer_load_dword v13, v8, s[16:19], s50 offen offset:128 sc1
    buffer_load_dword v14, v8, s[16:19], s50 offen offset:256 sc1
    buffer_load_dword v15, v8, s[16:19], s50 offen offset:384 sc1
    s_add_u32 s60, s60, 1
    s_waitcnt vmcnt(0)
    v_xor_b32 v12, s47, v12
    v_xor_b32 v13, s47, v13
    v_xor_b32 v14, s47, v14
    v_xor_b32 v15, s47, v15
    v_or3_b32 v12, v12, v13, v14
    v_or_b32 v12, v12, v15
    v_cmp_ne_u32 vcc, 0, v12
    s_cbranch_vccz L_epd
    s_sleep 4
    s_cmp_lt_u32 s60, 0x40000
    s_cbranch_scc1 L_ep
L_epd:
    v_mov_b32 v12, s47
    v_mov_b32 v13, 0
    s_mov_b32 s50, 18432
    s_mov_b64 exec, 1
    buffer_store_dword v12, v13, s[16:19], s50 offen sc1
L_noep:
L_end:
    s_endpgm
.section .rodata,"a"
.p2align 6
.amdhsa_kernel parallel_sum__spectral_fnet__geglu_ffn__prompt_kernel
  .amdhsa_next_free_vgpr 256
  .amdhsa_next_free_sgpr 102
  .amdhsa_accum_offset 256
  .amdhsa_group_segment_fixed_size 0
  .amdhsa_kernarg_size 96
  .amdhsa_user_sgpr_count 2
  .amdhsa_user_sgpr_kernarg_segment_ptr 1
  .amdhsa_system_sgpr_workgroup_id_x 1
.end_amdhsa_kernel
```
